```python
import torch

def _softmax(x, axis=-1):
    return torch.softmax(x, dim=axis)
def _gelu(x):
    return torch.nn.functional.gelu(x, approximate="tanh")
def _silu(x):
    return torch.nn.functional.silu(x)
def _sigmoid(x):
    return torch.sigmoid(x)
def _layernorm(x, axis=-1, eps=1e-5):
    m = x.mean(dim=axis, keepdim=True)
    v = x.var(dim=axis, keepdim=True, unbiased=False)
    return (x - m) / torch.sqrt(v + eps)
def _scatter_add(tgt, idx, src, axis=0):
    return tgt.clone().index_add_(axis, idx, src)
def _segment_sum(src, seg, n):
    out = torch.zeros((n,) + src.shape[1:], dtype=src.dtype)
    return out.index_add_(0, seg, src)
def _pad(x, pw):
    flat = tuple(v for pair in reversed(pw) for v in pair)
    return torch.nn.functional.pad(x, flat)

kernel_name = 'sequential_preLN__linear_kernel_hedgehog__glu_gated_bilinear__prompt'

def setup_inputs():

    _w = (lambda a: (lambda t: t.to(torch.bfloat16) if t.is_floating_point() else t)(torch.as_tensor(a)))
    def _A_setup():
        B, S, D, H = 1, 2048, 512, 32
        Dh = D // H
        return {
            "x": _w((lambda *s: torch.randn(*s, dtype=torch.bfloat16) * 0.05)(B, S, D)),
            "wqkv": _w((lambda *s: torch.randn(*s, dtype=torch.bfloat16) * 0.2)(D, 3 * D)),
            "w_phi": _w((lambda *s: torch.randn(*s, dtype=torch.bfloat16) * 0.2)(H, Dh, Dh) * (Dh ** -0.5)),
            "wo": _w((lambda *s: torch.randn(*s, dtype=torch.bfloat16) * 0.05)(D, D)),
        }
    _A_in = _A_setup()

    def _B_setup():
        B, S, D, F = 1, 2048, 512, 1376
        return {
            "x": _w((lambda *s: torch.randn(*s, dtype=torch.bfloat16) * 0.05)(B, S, D)),
            "w_gate": _w((lambda *s: torch.randn(*s, dtype=torch.bfloat16) * 0.4)(D, F) * (D ** -0.5)),
            "w_up": _w((lambda *s: torch.randn(*s, dtype=torch.bfloat16) * 0.4)(D, F) * (D ** -0.5)),
            "w_down": _w((lambda *s: torch.randn(*s, dtype=torch.bfloat16) * 0.4)(F, D) * (F ** -0.5)),
        }
    _B_in = _B_setup()

    return {
        "A_x": _A_in["x"],
        "A_wqkv": _A_in["wqkv"],
        "A_w_phi": _A_in["w_phi"],
        "A_wo": _A_in["wo"],
        "B_x": _B_in["x"],
        "B_w_gate": _B_in["w_gate"],
        "B_w_up": _B_in["w_up"],
        "B_w_down": _B_in["w_down"],
    }

def reference(A_x, A_wqkv, A_w_phi, A_wo, B_x, B_w_gate, B_w_up, B_w_down):
    def _A_ref(x, wqkv, w_phi, wo):
        B, S, D = x.shape
        H = 32; Dh = D // H
        qkv = (lambda x, *d: x.permute(*d))((x @ wqkv).reshape(B, S, 3, H, Dh), 2, 0, 3, 1, 4)
        q, k, v = qkv[0], qkv[1], qkv[2]
        pq = torch.einsum("bhsd,hdf->bhsf", q, w_phi)
        pk = torch.einsum("bhsd,hdf->bhsf", k, w_phi)
        phi_q = torch.concatenate([_softmax(pq, axis=-1), _softmax(-pq, axis=-1)], axis=-1)
        phi_k = torch.concatenate([_softmax(pk, axis=-1), _softmax(-pk, axis=-1)], axis=-1)
        kv = torch.einsum("bhsf,bhsd->bhfd", phi_k, v)
        z  = torch.einsum("bhsf->bhf", phi_k)
        num = torch.einsum("bhqf,bhfd->bhqd", phi_q, kv)
        den = torch.einsum("bhqf,bhf->bhq", phi_q, z)[..., None] + 1e-6
        o = num / den
        return (lambda x, *d: x.permute(*d))(o, 0, 2, 1, 3).reshape(B, S, D) @ wo

    def _B_ref(x, w_gate, w_up, w_down):
        g = torch.einsum("bsd,df->bsf", x, w_gate)
        u = torch.einsum("bsd,df->bsf", x, w_up)
        h = g * u
        return torch.einsum("bsf,fd->bsd", h, w_down)

    x = A_x
    h = x + _A_ref(_layernorm(x, axis=-1), A_wqkv, A_w_phi, A_wo)
    h2 = h + _B_ref(_layernorm(h, axis=-1), B_w_gate, B_w_up, B_w_down)
    return h2
```

```asm
; @launch grid=(256,1,1) block=(256,1,1) lds=163840
.amdgcn_target "amdgcn-amd-amdhsa--gfx950"
.text
.globl sequential_preLN__linear_kernel_hedgehog__glu_gated_bilinear__prompt_kernel
.p2align 8
.type sequential_preLN__linear_kernel_hedgehog__glu_gated_bilinear__prompt_kernel,@function
sequential_preLN__linear_kernel_hedgehog__glu_gated_bilinear__prompt_kernel:
    s_cmp_ge_u32 s2, 0x100
    s_cbranch_scc1 L_end
    s_load_dwordx2 s[8:9], s[0:1], 0
    s_load_dwordx2 s[12:13], s[0:1], 8
    s_load_dwordx2 s[40:41], s[0:1], 0x50
    s_load_dwordx2 s[16:17], s[0:1], 16
    s_load_dwordx2 s[20:21], s[0:1], 24
    s_load_dwordx2 s[28:29], s[0:1], 56
    s_load_dwordx2 s[32:33], s[0:1], 64
    s_load_dwordx4 s[92:95], s[0:1], 40
    v_lshrrev_b32 v24, 6, v0
    v_and_b32 v0, 63, v0
    v_readfirstlane_b32 s3, v24
    s_mov_b32 s10, 0x200000
    s_mov_b32 s11, 0x20000
    s_mov_b32 s14, 0x180000
    s_mov_b32 s15, 0x20000
    s_and_b32 s44, s2, 7
    s_lshr_b32 s49, s2, 3
    s_lshr_b32 s50, s2, 6
    s_lshl_b32 s4, s44, 2
    s_add_u32 s4, s4, s50
    s_and_b32 s5, s49, 7
    s_mul_i32 s44, s44, 1
    s_mul_i32 s51, s5, 1
    s_add_u32 s44, s44, s51
    s_mul_i32 s51, s50, 2
    s_add_u32 s44, s44, s51
    s_and_b32 s44, s44, 7
    v_lshrrev_b32 v20, 3, v0
    v_and_b32 v21, 7, v0
    v_lshl_add_u32 v24, v24, 4, v20
    v_and_b32 v22, 6, v20
    v_xor_b32 v22, v22, v21
    v_lshlrev_b32 v22, 4, v22
    v_lshl_add_u32 v2, v24, 10, v22
    v_add_u32 v3, 0x1c00, v2
    s_lshl_b32 s62, s3, 11
    s_lshl_b32 s63, s3, 12
    s_lshl_b32 s64, s4, 16
    s_lshl_b32 s50, s5, 7
    v_and_b32 v22, 2, v20
    v_xor_b32 v22, v22, v21
    v_lshl_add_u32 v22, v22, 4, s50
    v_xor_b32 v23, 64, v22
    v_mul_u32_u24 v24, 0xc00, v24
    s_mov_b32 s51, 0x400
    s_mov_b32 s52, 0x5c00
    v_add3_u32 v4, v24, v22, s51
    v_add3_u32 v5, v24, v23, s52
    s_mul_i32 s80, s44, 0x30000
    s_add_u32 s81, s44, 1
    s_and_b32 s81, s81, 7
    s_mul_i32 s81, s81, 0x30000
    s_getpc_b64 s[36:37]
L_pc:
    s_mov_b32 s38, L_end-L_pc
    s_mov_b32 s39, 0x20000
    s_lshl_b32 s97, s49, 2
    s_add_u32 s97, s97, s3
    s_lshl_b32 s68, s97, 9
    v_lshlrev_b32 v68, 7, v0
    s_mov_b64 exec, 15
    buffer_load_dword v69, v68, s[36:39], s68 offen
    s_mov_b64 exec, -1
    s_add_u32 s82, s44, 2
    s_and_b32 s82, s82, 7
    s_mul_i32 s82, s82, 0x30000
    s_add_u32 s83, s44, 3
    s_and_b32 s83, s83, 7
    s_mul_i32 s83, s83, 0x30000
    s_add_u32 s84, s44, 4
    s_and_b32 s84, s84, 7
    s_mul_i32 s84, s84, 0x30000
    s_add_u32 s85, s44, 5
    s_and_b32 s85, s85, 7
    s_mul_i32 s85, s85, 0x30000
    s_add_u32 s86, s44, 6
    s_and_b32 s86, s86, 7
    s_mul_i32 s86, s86, 0x30000
    s_add_u32 s87, s44, 7
    s_and_b32 s87, s87, 7
    s_mul_i32 s87, s87, 0x30000
    s_waitcnt lgkmcnt(0)
    s_add_u32 m0, s62, 0
    s_lshl_b32 s65, s44, 7
    s_add_u32 s65, s65, s64
    buffer_load_dwordx4 v2, s[8:11], s65 offen offset:0 nt lds
    buffer_load_dwordx4 v3, s[8:11], s65 offen offset:1024 nt lds
    s_add_u32 m0, s63, 0x10000
    s_nop 0
    buffer_load_dwordx4 v4, s[12:15], s80 offen offset:0 lds
    buffer_load_dwordx4 v5, s[12:15], s80 offen offset:2048 lds
    s_add_u32 m0, s63, 0x10400
    s_nop 0
    buffer_load_dwordx4 v4, s[12:15], s81 offen offset:0 lds
    buffer_load_dwordx4 v5, s[12:15], s81 offen offset:2048 lds
    s_add_u32 s65, s44, 1
    s_and_b32 s65, s65, 7
    s_add_u32 m0, s62, 0x2000
    s_lshl_b32 s65, s65, 7
    s_add_u32 s65, s65, s64
    buffer_load_dwordx4 v2, s[8:11], s65 offen offset:0 nt lds
    buffer_load_dwordx4 v3, s[8:11], s65 offen offset:1024 nt lds
    s_mov_b32 s18, 0x4000
    s_mov_b32 s19, 0x20000
    s_mov_b32 s22, 0x80000
    s_mov_b32 s23, 0x20000
    s_mov_b32 s26, 0x158000
    s_mov_b32 s27, 0x20000
    s_mov_b32 s30, 0x158000
    s_mov_b32 s31, 0x20000
    s_mov_b32 s34, 0x200000
    s_mov_b32 s35, 0x20000
    s_mov_b32 s42, 0x1000000
    s_mov_b32 s43, 0x20000
    s_bitcmp1_b32 s3, 0
    s_cselect_b64 s[24:25], s[94:95], s[92:93]
    s_lshl_b32 s69, s2, 2
    s_add_u32 s69, s69, s3
    v_lshlrev_b32 v68, 7, v0
    s_lshr_b32 s68, s69, 1
    s_mul_i32 s68, s68, 0x800
    s_lshl_b32 s69, s69, 9
    s_add_u32 s68, s68, s69
    s_add_u32 s68, s68, 0x800
    s_mov_b64 exec, 15
    buffer_load_dword v69, v68, s[12:15], s68 offen
    s_mov_b64 exec, -1
    s_lshl_b32 s69, s2, 2
    s_add_u32 s69, s69, s3
    v_lshlrev_b32 v68, 7, v0
    s_lshr_b32 s68, s69, 1
    s_mul_i32 s68, s68, 0x800
    s_lshl_b32 s69, s69, 9
    s_add_u32 s68, s68, s69
    s_mov_b64 exec, 15
    buffer_load_dword v69, v68, s[12:15], s68 offen
    s_mov_b64 exec, -1
    s_lshl_b32 s69, s2, 2
    s_add_u32 s69, s69, s3
    v_lshlrev_b32 v68, 7, v0
    s_lshl_b32 s68, s69, 9
    s_mov_b64 exec, 15
    buffer_load_dword v69, v68, s[20:23], s68 offen
    s_mov_b64 exec, -1
    v_lshlrev_b32 v1, 4, v0
    s_lshl_b32 s45, s5, 2
    s_add_u32 s45, s45, s3
    v_cmp_gt_u32 vcc, 32, v0
    v_mov_b32 v17, 0x40000000
    s_nop 0
    v_cndmask_b32 v25, v17, v1, vcc
    v_cmp_eq_u32 vcc, 0, v0
    s_lshl_b32 s50, s3, 10
    s_add_u32 m0, s50, 0x25000
    v_cndmask_b32 v17, v17, v0, vcc
    s_lshl_b32 s50, s45, 9
    buffer_load_dwordx4 v25, s[16:19], s50 offen offset:0 lds
    buffer_load_dword v16, v17, s[40:43], 0 offen sc1
    s_lshr_b32 s6, s4, 1
    s_xor_b32 s7, s5, 4
    s_lshl_b32 s7, s7, 1
    s_and_b32 s50, s4, 1
    s_add_u32 s7, s7, s50
    v_lshl_add_u32 v6, v20, 10, v22
    v_lshl_add_u32 v7, v20, 10, v23
    v_add_u32 v8, 0x3800, v6
    v_add_u32 v9, 0x5400, v7
    v_add_u32 v7, 0x1c00, v7
    v_lshlrev_b32 v22, 4, v21
    v_lshl_add_u32 v80, v20, 12, v22
    v_and_b32 v14, 15, v0
    v_lshrrev_b32 v15, 4, v0
    v_lshlrev_b32 v22, 4, v14
    v_lshrrev_b32 v23, 1, v15
    v_and_b32 v24, 1, v15
    s_mov_b32 s50, 0x2d000
    v_mad_u32_u24 v71, s50, v23, v22
    v_lshl_add_u32 v22, v23, 8, v22
    v_mad_u32_u24 v70, s50, v24, v22
    s_cmp_eq_u32 s7, 15
    s_cselect_b32 s50, 0x40000000, 0
    v_lshl_or_b32 v71, v24, 30, v71
    v_mov_b32 v23, 0x40000000
    v_mov_b32 v35, 0x40000000
    v_or_b32 v71, s50, v71
    v_or_b32 v70, s50, v70
    s_and_b32 s51, s3, 1
    v_lshl_add_u32 v18, v24, 14, v22
    s_lshl_b32 s93, s45, 9
    s_add_u32 s93, s93, s64
    s_lshl_b32 s94, s4, 3
    s_add_u32 s94, s94, s5
    s_lshl_b32 s94, s94, 9
    s_lshl_b32 s50, s51, 8
    s_add_u32 s94, s94, s50
    s_add_u32 s94, s94, 0x2e0000
    s_mul_i32 s98, s6, 0x5a000
    s_mul_i32 s50, s7, 0xc00
    s_add_u32 s98, s98, s50
    s_mul_i32 s50, s3, 0x300
    s_add_u32 s98, s98, s50
    s_add_u32 s98, s98, 0x800000
    v_lshlrev_b32 v22, 9, v15
    v_lshl_add_u32 v22, v14, 11, v22
    v_cmp_gt_u32 vcc, 2, v14
    s_nop 1
    v_cndmask_b32 v81, v23, v22, vcc
    v_bfe_u32 v20, v0, 2, 2
    v_and_b32 v21, 3, v0
    v_bfe_u32 v22, v0, 3, 2
    v_lshlrev_b32 v23, 7, v20
    v_lshl_add_u32 v23, v21, 3, v23
    v_lshl_add_u32 v26, v15, 10, v23
    s_lshl_b32 s92, s3, 14
    s_lshl_b32 s95, s3, 15
    s_add_u32 s52, s92, 0x10000
    v_add_u32 v19, s52, v26
    s_add_u32 s50, s3, 0
    s_and_b32 s50, s50, 3
    v_xor_b32 v24, s50, v22
    v_lshl_add_u32 v10, v24, 5, v19
    s_add_u32 s50, s3, 1
    s_and_b32 s50, s50, 3
    v_xor_b32 v24, s50, v22
    v_lshl_add_u32 v11, v24, 5, v19
    s_add_u32 s50, s3, 2
    s_and_b32 s50, s50, 3
    v_xor_b32 v24, s50, v22
    v_lshl_add_u32 v12, v24, 5, v19
    s_add_u32 s50, s3, 3
    s_and_b32 s50, s50, 3
    v_xor_b32 v24, s50, v22
    v_lshl_add_u32 v13, v24, 5, v19
    v_lshl_add_u32 v23, v15, 11, v23
    v_add_u32 v23, 0x10000, v23
    v_xor_b32 v24, s3, v22
    v_lshl_add_u32 v19, v24, 5, v23
    v_add_u32 v85, 0x10000, v19
    v_lshl_add_u32 v23, v14, 7, s62
    v_and_b32 v22, 6, v14
    v_xor_b32 v22, v22, v15
    v_lshl_add_u32 v72, v22, 4, v23
    v_xor_b32 v73, 64, v72
    v_xor_b32 v74, 0x800, v72
    v_xor_b32 v75, 0x840, v72
    v_xor_b32 v76, 0x1000, v72
    v_xor_b32 v77, 0x1040, v72
    v_xor_b32 v78, 0x1800, v72
    v_xor_b32 v79, 0x1840, v72
    v_mov_b32 v28, 0x3f803f80
    v_mov_b32 v29, 0x3f803f80
    v_mov_b32 v30, 0x3f803f80
    v_mov_b32 v31, 0x3f803f80
    v_cmp_eq_u32 s[54:55], v20, v15
    v_cmp_eq_u32 s[56:57], 1, v21
    v_cmp_eq_u32 s[58:59], 2, v21
    v_cmp_eq_u32 s[60:61], 3, v21
    s_lshl_b32 s50, s3, 10
    s_add_u32 s50, s50, 0x25000
    v_lshrrev_b32 v24, 2, v0
    v_lshl_add_u32 v22, v24, 5, s50
    s_add_u32 s50, s50, 0x200
    v_mov_b32 v23, s50
    v_cmp_eq_u32 vcc, 0, v21
    s_nop 1
    v_cndmask_b32 v88, v23, v22, vcc
    v_cndmask_b32 v89, v23, v22, s[56:57]
    v_cndmask_b32 v90, v23, v22, s[58:59]
    v_cndmask_b32 v91, v23, v22, s[60:61]
    s_mul_i32 s50, s3, 0x1400
    s_add_u32 s50, s50, 0x20000
    s_mov_b32 s51, 0x50
    v_mov_b32 v23, s50
    v_mad_u32_u24 v82, s51, v0, v23
    v_mad_u32_u24 v22, s51, v24, v23
    v_lshl_add_u32 v83, v21, 4, v22
    v_mad_u32_u24 v22, s51, v14, v23
    v_lshl_add_u32 v84, v15, 4, v22
    v_mov_b32 v87, 0xff
    s_add_u32 s65, s44, 2
    s_and_b32 s65, s65, 7
    s_add_u32 m0, s62, 0x4000
    s_lshl_b32 s65, s65, 7
    s_add_u32 s65, s65, s64
    buffer_load_dwordx4 v2, s[8:11], s65 offen offset:0 nt lds
    buffer_load_dwordx4 v3, s[8:11], s65 offen offset:1024 nt lds
    s_add_u32 s65, s44, 3
    s_and_b32 s65, s65, 7
    s_add_u32 m0, s62, 0x6000
    s_lshl_b32 s65, s65, 7
    s_add_u32 s65, s65, s64
    buffer_load_dwordx4 v2, s[8:11], s65 offen offset:0 nt lds
    buffer_load_dwordx4 v3, s[8:11], s65 offen offset:1024 nt lds
    s_lshr_b32 s50, s3, 1
    s_and_b32 s51, s3, 1
    s_mul_i32 s67, s50, 0x2b000
    s_mul_i32 s52, s51, 0x3000
    s_mul_i32 s66, s50, 0x6000
    s_add_u32 s66, s66, s52
    s_mul_i32 s50, s7, 0xc0
    s_add_u32 s67, s67, s50
    s_mul_i32 s50, s7, -12
    s_add_u32 s50, s50, 0xab
    s_and_b32 s0, s2, 7
    s_mul_i32 s0, s0, 1
    s_and_b32 s52, s6, 1
    s_mul_i32 s52, s52, 0
    s_add_u32 s0, s0, s52
    s_and_b32 s0, s0, 3
    s_mov_b32 s52, 0xac0
    v_add_u32 v20, 0, v0
    v_mul_u32_u24 v21, 0xaaab, v20
    v_lshrrev_b32 v21, 19, v21
    v_mad_i32_i24 v20, v21, -12, v20
    v_lshrrev_b32 v22, 2, v21
    v_and_or_b32 v22, v22, 2, s51
    v_xor_b32 v20, v20, v22
    v_sub_u32 v22, s50, v20
    v_and_b32 v22, 0x40000000, v22
    v_lshl_add_u32 v20, v20, 4, v22
    v_mad_u32_u24 v32, v21, s52, v20
    v_add_u32 v20, 64, v0
    v_mul_u32_u24 v21, 0xaaab, v20
    v_lshrrev_b32 v21, 19, v21
    v_mad_i32_i24 v20, v21, -12, v20
    v_lshrrev_b32 v22, 2, v21
    v_and_or_b32 v22, v22, 2, s51
    v_xor_b32 v20, v20, v22
    v_sub_u32 v22, s50, v20
    v_and_b32 v22, 0x40000000, v22
    v_lshl_add_u32 v20, v20, 4, v22
    v_mad_u32_u24 v33, v21, s52, v20
    v_subrev_u32 v33, 0x400, v33
    v_add_u32 v20, 0x80, v0
    v_mul_u32_u24 v21, 0xaaab, v20
    v_lshrrev_b32 v21, 19, v21
    v_mad_i32_i24 v20, v21, -12, v20
    v_lshrrev_b32 v22, 2, v21
    v_and_or_b32 v22, v22, 2, s51
    v_xor_b32 v20, v20, v22
    v_sub_u32 v22, s50, v20
    v_and_b32 v22, 0x40000000, v22
    v_lshl_add_u32 v20, v20, 4, v22
    v_mad_u32_u24 v34, v21, s52, v20
    v_subrev_u32 v34, 0x800, v34
    v_bfe_u32 v20, v0, 2, 2
    v_lshl_add_u32 v20, v15, 3, v20
    v_mul_u32_u24 v20, 0xc0, v20
    v_and_b32 v21, 1, v0
    v_lshl_add_u32 v20, v21, 3, v20
    v_bfe_u32 v23, v0, 1, 1
    v_lshrrev_b32 v22, 3, v0
    v_and_b32 v22, 2, v22
    s_mul_i32 s50, s3, 3
    v_add_u32 v21, s50, v23
    v_xor_b32 v21, v21, v22
    v_lshl_add_u32 v44, v21, 4, v20
    v_xor_b32 v45, 16, v44
    v_add_u32 v45, 0x3000, v45
    s_add_u32 s50, s50, 2
    v_xor_b32 v21, s50, v22
    v_xor_b32 v21, v21, v23
    v_lshl_add_u32 v20, v21, 4, v20
    s_mov_b32 s52, 0x3000
    v_mad_u32_u24 v46, v23, s52, v20
    s_lshr_b32 s50, s4, 2
    s_lshl_b32 s50, s50, 1
    s_and_b32 s51, s4, 1
    s_add_u32 s50, s50, s51
    s_bitcmp1_b32 s4, 1
    s_cselect_b32 s50, 31, s50
    s_cselect_b32 s51, 0x40000000, 0
    s_cselect_b32 s52, 0, 0xff
    v_mov_b32 v39, s52
    s_lshl_b32 s52, s50, 12
    s_add_u32 s52, s52, s51
    v_add_u32 v37, s52, v1
    s_lshl_b32 s52, s50, 7
    s_add_u32 s52, s52, s51
    v_add_u32 v25, s52, v1
    v_mov_b32 v26, 0x40000000
    v_cmp_gt_u32 vcc, 8, v0
    s_nop 1
    v_cndmask_b32 v36, v26, v25, vcc
    s_add_u32 s52, s52, 0x800
    s_cmp_lt_u32 s50, 8
    s_cselect_b32 s52, s52, 0x40000000
    s_cselect_b32 s51, 0, 4
    s_cselect_b32 s100, 0xff, 0
    s_cmp_lt_u32 s50, 4
    s_cselect_b32 s101, 0x100, 0
    s_or_b32 s100, s100, s101
    s_mov_b32 s101, 0
    v_writelane_b32 v36, s52, 8
    v_lshrrev_b32 v25, 1, v1
    v_and_b32 v25, 0x1c0, v25
    v_and_or_b32 v25, v1, 48, v25
    s_lshl_b32 s52, s50, 9
    s_add_u32 s52, s52, 0x10000
    v_add_u32 v25, s52, v25
    v_and_or_b32 v40, v0, 4, s51
    v_cmp_eq_u32 vcc, 0, v40
    s_nop 1
    v_cndmask_b32 v38, v26, v25, vcc
    v_cndmask_b32 v40, 0, v87, vcc
    s_sub_u32 s50, s5, s44
    s_and_b32 s50, s50, 7
    s_lshl_b32 s50, s50, 13
    s_lshl_b32 s51, s3, 1
    v_lshrrev_b32 v25, 1, v15
    v_add_u32 v25, s51, v25
    v_and_b32 v26, 6, v14
    v_xor_b32 v25, v25, v26
    v_lshl_add_u32 v25, v25, 4, s50
    v_lshl_add_u32 v25, v14, 7, v25
    v_and_b32 v26, 1, v15
    v_lshl_add_u32 v25, v26, 3, v25
    s_waitcnt vmcnt(13)
    s_barrier
    ds_read_b64_tr_b16 v[196:197], v19 offset:0
    ds_read_b64_tr_b16 v[198:199], v19 offset:512
    ds_read_b128 a[0:3], v72 offset:0
    ds_read_b128 a[4:7], v74 offset:0
    ds_read_b128 a[8:11], v76 offset:0
    ds_read_b128 a[12:15], v78 offset:0
    s_waitcnt lgkmcnt(4)
    v_mfma_f32_16x16x32_bf16 v[176:179], v[196:199], v[28:31], 0
    s_waitcnt lgkmcnt(3)
    ds_read_b128 a[16:19], v73 offset:0
    ds_read_b64_tr_b16 v[200:201], v19 offset:8192
    s_add_u32 s65, s44, 4
    s_and_b32 s65, s65, 7
    v_mfma_f32_16x16x32_bf16 v[128:131], v[196:199], a[0:3], 0
    s_waitcnt lgkmcnt(4)
    ds_read_b64_tr_b16 v[202:203], v19 offset:8704
    ds_read_b128 a[20:23], v75 offset:0
    s_add_u32 m0, s62, 0x8000
    s_lshl_b32 s65, s65, 7
    v_mfma_f32_16x16x32_bf16 v[132:135], v[196:199], a[4:7], 0
    s_waitcnt lgkmcnt(5)
    ds_read_b128 a[24:27], v77 offset:0
    ds_read_b128 a[28:31], v79 offset:0
    s_add_u32 s65, s65, s64
    v_mfma_f32_16x16x32_bf16 v[136:139], v[196:199], a[8:11], 0
    s_waitcnt lgkmcnt(6)
    buffer_load_dwordx4 v2, s[8:11], s65 offen offset:0 nt lds
    v_mfma_f32_16x16x32_bf16 v[140:143], v[196:199], a[12:15], 0
    buffer_load_dwordx4 v3, s[8:11], s65 offen offset:1024 nt lds
    s_add_u32 s65, s44, 5
    s_and_b32 s65, s65, 7
    s_add_u32 m0, s62, 0xa000
    v_mfma_f32_16x16x32_bf16 v[188:191], v[28:31], a[0:3], 0
    s_lshl_b32 s65, s65, 7
    s_add_u32 s65, s65, s64
    buffer_load_dwordx4 v2, s[8:11], s65 offen offset:0 nt lds
    v_mfma_f32_16x16x32_bf16 v[192:195], a[0:3], a[0:3], 0
    s_waitcnt lgkmcnt(5)
    buffer_load_dwordx4 v3, s[8:11], s65 offen offset:1024 nt lds
    v_mfma_f32_16x16x32_bf16 v[188:191], v[28:31], a[16:19], v[188:191]
    s_waitcnt vmcnt(13)
    s_barrier
    v_mfma_f32_16x16x32_bf16 v[192:195], a[16:19], a[16:19], v[192:195]
    s_waitcnt lgkmcnt(3)
    ds_read_b64_tr_b16 v[204:205], v19 offset:1024
    ds_read_b64_tr_b16 v[206:207], v19 offset:1536
    ds_read_b128 a[32:35], v72 offset:8192
    v_mfma_f32_16x16x32_bf16 v[176:179], v[200:203], v[28:31], v[176:179]
    ds_read_b128 a[36:39], v74 offset:8192
    ds_read_b128 a[40:43], v76 offset:8192
    ds_read_b128 a[44:47], v78 offset:8192
    v_mfma_f32_16x16x32_bf16 v[128:131], v[200:203], a[16:19], v[128:131]
    s_waitcnt lgkmcnt(8)
    ds_read_b128 a[48:51], v73 offset:8192
    s_add_u32 s65, s44, 6
    s_and_b32 s65, s65, 7
    s_add_u32 m0, s62, 0xc000
    v_mfma_f32_16x16x32_bf16 v[132:135], v[200:203], a[20:23], v[132:135]
    s_waitcnt lgkmcnt(8)
    s_lshl_b32 s65, s65, 7
    s_add_u32 s65, s65, s64
    s_waitcnt vmcnt(9)
    v_mfma_f32_16x16x32_bf16 v[136:139], v[200:203], a[24:27], v[136:139]
    s_waitcnt lgkmcnt(7)
    ds_read_b64_tr_b16 v[208:209], v19 offset:9216
    buffer_load_dwordx4 v2, s[8:11], s65 offen offset:0 nt lds
    v_mfma_f32_16x16x32_bf16 v[140:143], v[200:203], a[28:31], v[140:143]
    s_waitcnt lgkmcnt(6)
    ds_read_b64_tr_b16 v[210:211], v19 offset:9728
    buffer_load_dwordx4 v3, s[8:11], s65 offen offset:1024 nt lds
    v_mfma_f32_16x16x32_bf16 v[176:179], v[204:207], v[28:31], v[176:179]
    s_waitcnt lgkmcnt(6)
    ds_read_b128 a[52:55], v75 offset:8192
    s_add_u32 s65, s44, 7
    s_and_b32 s65, s65, 7
    s_add_u32 m0, s62, 0xe000
    v_mfma_f32_16x16x32_bf16 v[128:131], v[204:207], a[32:35], v[128:131]
    s_waitcnt lgkmcnt(6)
    ds_read_b128 a[56:59], v77 offset:8192
    s_lshl_b32 s65, s65, 7
    s_add_u32 s65, s65, s64
    v_mfma_f32_16x16x32_bf16 v[132:135], v[204:207], a[36:39], v[132:135]
    s_waitcnt lgkmcnt(6)
    ds_read_b128 a[60:63], v79 offset:8192
    buffer_load_dwordx4 v2, s[8:11], s65 offen offset:0 nt lds
    v_mfma_f32_16x16x32_bf16 v[136:139], v[204:207], a[40:43], v[136:139]
    s_waitcnt lgkmcnt(6)
    buffer_load_dwordx4 v3, s[8:11], s65 offen offset:1024 nt lds
    v_mfma_f32_16x16x32_bf16 v[140:143], v[204:207], a[44:47], v[140:143]
    ds_read_b64_tr_b16 v[96:97], v88 offset:0
    ds_read_b64_tr_b16 v[98:99], v89 offset:0
    v_mfma_f32_16x16x32_bf16 v[188:191], v[28:31], a[32:35], v[188:191]
    ds_read_b64_tr_b16 v[100:101], v90 offset:0
    ds_read_b64_tr_b16 v[102:103], v91 offset:0
    v_mfma_f32_16x16x32_bf16 v[192:195], a[32:35], a[32:35], v[192:195]
    s_waitcnt lgkmcnt(9)
    ds_read_b64_tr_b16 v[104:105], v88 offset:8
    ds_read_b64_tr_b16 v[106:107], v89 offset:8
    v_mfma_f32_16x16x32_bf16 v[188:191], v[28:31], a[48:51], v[188:191]
    s_waitcnt vmcnt(8)
    s_barrier
    v_mfma_f32_16x16x32_bf16 v[192:195], a[48:51], a[48:51], v[192:195]
    s_waitcnt lgkmcnt(9)
    ds_read_b128 a[64:67], v72 offset:16384
    ds_read_b128 a[80:83], v73 offset:16384
    ds_read_b128 a[96:99], v72 offset:24576
    ds_read_b128 a[112:115], v73 offset:24576
    v_mfma_f32_16x16x32_bf16 v[176:179], v[208:211], v[28:31], v[176:179]
    s_add_u32 m0, s63, 0x14000
    s_nop 0
    buffer_load_dwordx4 v4, s[12:15], s82 offen offset:0 lds
    ds_read_b128 a[68:71], v74 offset:16384
    ds_read_b128 a[72:75], v76 offset:16384
    v_mfma_f32_16x16x32_bf16 v[128:131], v[208:211], a[48:51], v[128:131]
    s_waitcnt lgkmcnt(14)
    buffer_load_dwordx4 v5, s[12:15], s82 offen offset:2048 lds
    ds_read_b128 a[76:79], v78 offset:16384
    ds_read_b128 a[84:87], v75 offset:16384
    v_mfma_f32_16x16x32_bf16 v[132:135], v[208:211], a[52:55], v[132:135]
    s_waitcnt lgkmcnt(15)
    s_add_u32 m0, s63, 0x14400
    ds_read_b128 a[88:91], v77 offset:16384
    ds_read_b128 a[92:95], v79 offset:16384
    ds_read_b128 a[100:103], v74 offset:24576
    v_mfma_f32_16x16x32_bf16 v[136:139], v[208:211], a[56:59], v[136:139]
    s_waitcnt lgkmcnt(15)
    buffer_load_dwordx4 v4, s[12:15], s83 offen offset:0 lds
    ds_read_b128 a[104:107], v76 offset:24576
    ds_read_b128 a[108:111], v78 offset:24576
    v_mfma_f32_16x16x32_bf16 v[140:143], v[208:211], a[60:63], v[140:143]
    s_waitcnt lgkmcnt(12)
    buffer_load_dwordx4 v5, s[12:15], s83 offen offset:2048 lds
    ds_read_b128 a[116:119], v75 offset:24576
    ds_read_b128 a[120:123], v77 offset:24576
    v_mfma_f32_16x16x32_bf16 v[188:191], v[28:31], a[64:67], v[188:191]
    ds_read_b128 a[124:127], v79 offset:24576
    ds_read_b64_tr_b16 v[108:109], v90 offset:8
    v_mfma_f32_16x16x32_bf16 v[192:195], a[64:67], a[64:67], v[192:195]
    s_waitcnt lgkmcnt(15)
    s_waitcnt vmcnt(8)
    s_barrier
    v_mfma_f32_16x16x32_bf16 v[188:191], v[28:31], a[80:83], v[188:191]
    ds_read_b128 a[128:131], v72 offset:32768
    ds_read_b128 a[144:147], v73 offset:32768
    ds_read_b128 a[160:163], v72 offset:40960
    ds_read_b128 a[176:179], v73 offset:40960
    v_mfma_f32_16x16x32_bf16 v[192:195], a[80:83], a[80:83], v[192:195]
    s_waitcnt lgkmcnt(15)
    s_add_u32 m0, s63, 0x18000
    ds_read_b128 a[132:135], v74 offset:32768
    ds_read_b128 a[136:139], v76 offset:32768
    ds_read_b128 a[140:143], v78 offset:32768
    v_mfma_f32_16x16x32_bf16 v[188:191], v[28:31], a[96:99], v[188:191]
    buffer_load_dwordx4 v4, s[12:15], s84 offen offset:0 lds
    ds_read_b128 a[148:151], v75 offset:32768
    ds_read_b128 a[152:155], v77 offset:32768
    v_mfma_f32_16x16x32_bf16 v[192:195], a[96:99], a[96:99], v[192:195]
    buffer_load_dwordx4 v5, s[12:15], s84 offen offset:2048 lds
    ds_read_b128 a[156:159], v79 offset:32768
    ds_read_b128 a[164:167], v74 offset:40960
    v_mfma_f32_16x16x32_bf16 v[188:191], v[28:31], a[112:115], v[188:191]
    s_add_u32 m0, s63, 0x18400
    s_nop 0
    buffer_load_dwordx4 v4, s[12:15], s85 offen offset:0 lds
    ds_read_b128 a[168:171], v76 offset:40960
    ds_read_b128 a[172:175], v78 offset:40960
    v_mfma_f32_16x16x32_bf16 v[192:195], a[112:115], a[112:115], v[192:195]
    s_waitcnt lgkmcnt(12)
    buffer_load_dwordx4 v5, s[12:15], s85 offen offset:2048 lds
    ds_read_b128 a[180:183], v75 offset:40960
    ds_read_b128 a[184:187], v77 offset:40960
    v_mfma_f32_16x16x32_bf16 v[188:191], v[28:31], a[128:131], v[188:191]
    ds_read_b128 a[188:191], v79 offset:40960
    ds_read_b64_tr_b16 v[110:111], v91 offset:8
    v_mfma_f32_16x16x32_bf16 v[192:195], a[128:131], a[128:131], v[192:195]
    s_waitcnt lgkmcnt(15)
    s_waitcnt vmcnt(8)
    s_barrier
    v_mfma_f32_16x16x32_bf16 v[188:191], v[28:31], a[144:147], v[188:191]
    ds_read_b128 a[192:195], v72 offset:49152
    ds_read_b128 a[208:211], v73 offset:49152
    ds_read_b128 a[224:227], v72 offset:57344
    ds_read_b128 a[240:243], v73 offset:57344
    ds_read_b128 a[196:199], v74 offset:49152
    ds_read_b128 a[200:203], v76 offset:49152
    v_mfma_f32_16x16x32_bf16 v[192:195], a[144:147], a[144:147], v[192:195]
    s_waitcnt lgkmcnt(15)
    s_add_u32 m0, s63, 0x1c000
    s_nop 0
    buffer_load_dwordx4 v4, s[12:15], s86 offen offset:0 lds
    ds_read_b128 a[204:207], v78 offset:49152
    ds_read_b128 a[212:215], v75 offset:49152
    ds_read_b128 a[216:219], v77 offset:49152
    ds_read_b128 a[220:223], v79 offset:49152
    v_mfma_f32_16x16x32_bf16 v[188:191], v[28:31], a[160:163], v[188:191]
    buffer_load_dwordx4 v5, s[12:15], s86 offen offset:2048 lds
    s_add_u32 m0, s63, 0x1c400
    s_nop 0
    buffer_load_dwordx4 v4, s[12:15], s87 offen offset:0 lds
    ds_read_b128 a[228:231], v74 offset:57344
    ds_read_b128 a[232:235], v76 offset:57344
    ds_read_b128 a[236:239], v78 offset:57344
    v_mfma_f32_16x16x32_bf16 v[192:195], a[160:163], a[160:163], v[192:195]
    buffer_load_dwordx4 v5, s[12:15], s87 offen offset:2048 lds
    v_mov_b32 v160, 0
    v_mov_b32 v161, 0
    v_mov_b32 v162, 0
    ds_read_b128 a[244:247], v75 offset:57344
    ds_read_b128 a[248:251], v77 offset:57344
    v_mfma_f32_16x16x32_bf16 v[188:191], v[28:31], a[176:179], v[188:191]
    v_mov_b32 v163, 0
    s_add_u32 s68, s93, 0x500000
    buffer_store_dwordx4 v[160:163], v18, s[40:43], s68 offen sc1
    s_add_u32 s68, s93, 0x508000
    ds_read_b128 a[252:255], v79 offset:57344
    v_mfma_f32_16x16x32_bf16 v[192:195], a[176:179], a[176:179], v[192:195]
    s_waitcnt lgkmcnt(15)
    buffer_store_dwordx4 v[160:163], v18, s[40:43], s68 offen sc1
    v_mfma_f32_16x16x32_bf16 v[188:191], v[28:31], a[192:195], v[188:191]
    s_mul_i32 s68, s97, 0x3000
    s_add_u32 s68, s68, 0x180
    v_lshlrev_b32 v68, 10, v0
    s_mov_b64 exec, 0xfff
    buffer_load_dword v69, v68, s[12:15], s68 offen
    s_mov_b64 exec, -1
    v_mfma_f32_16x16x32_bf16 v[192:195], a[192:195], a[192:195], v[192:195]
    s_waitcnt lgkmcnt(14)
    s_waitcnt vmcnt(11)
    s_barrier
    v_mfma_f32_16x16x32_bf16 v[188:191], v[28:31], a[208:211], v[188:191]
    ds_read_b64_tr_b16 v[196:197], v19 offset:16384
    s_add_u32 m0, s63, 0x1fc00
    ds_read_b64_tr_b16 v[112:113], v88 offset:16
    v_mfma_f32_16x16x32_bf16 v[192:195], a[208:211], a[208:211], v[192:195]
    s_waitcnt lgkmcnt(15)
    ds_read_b64_tr_b16 v[198:199], v19 offset:16896
    ds_read_b64_tr_b16 v[114:115], v89 offset:16
    v_mfma_f32_16x16x32_bf16 v[188:191], v[28:31], a[224:227], v[188:191]
    ds_read_b64_tr_b16 v[200:201], v19 offset:24576
    ds_read_b64_tr_b16 v[116:117], v90 offset:16
    v_mfma_f32_16x16x32_bf16 v[192:195], a[224:227], a[224:227], v[192:195]
    s_waitcnt lgkmcnt(15)
    ds_read_b64_tr_b16 v[202:203], v19 offset:25088
    ds_read_b64_tr_b16 v[118:119], v91 offset:16
    v_mfma_f32_16x16x32_bf16 v[188:191], v[28:31], a[240:243], v[188:191]
    buffer_load_dwordx4 v4, s[12:15], s80 offen offset:1024 lds
    ds_read_b64_tr_b16 v[120:121], v88 offset:24
    v_mfma_f32_16x16x32_bf16 v[192:195], a[240:243], a[240:243], v[192:195]
    s_waitcnt lgkmcnt(6)
    ds_read_b64_tr_b16 v[204:205], v19 offset:17408
    ds_read_b64_tr_b16 v[122:123], v89 offset:24
    v_mfma_f32_16x16x32_bf16 v[176:179], v[196:199], v[28:31], v[176:179]
    ds_read_b64_tr_b16 v[206:207], v19 offset:17920
    ds_read_b64_tr_b16 v[124:125], v90 offset:24
    v_mfma_f32_16x16x32_bf16 v[128:131], v[196:199], a[64:67], v[128:131]
    buffer_load_dwordx4 v5, s[12:15], s80 offen offset:3072 lds
    v_cndmask_b32 v20, v192, v193, s[56:57]
    v_mfma_f32_16x16x32_bf16 v[132:135], v[196:199], a[68:71], v[132:135]
    s_add_u32 m0, s63, 0x20000
    ds_read_b64 v[48:49], v25 offset:0
    v_mul_f32 v21, 0xbb000000, v188
    v_cndmask_b32 v20, v20, v194, s[58:59]
    v_mfma_f32_16x16x32_bf16 v[136:139], v[196:199], a[72:75], v[136:139]
    buffer_load_dwordx4 v4, s[12:15], s81 offen offset:1024 lds
    s_lshl_b32 s50, s3, 6
    v_mfma_f32_16x16x32_bf16 v[140:143], v[196:199], a[76:79], v[140:143]
    s_waitcnt lgkmcnt(7)
    ds_read_b64_tr_b16 v[208:209], v19 offset:25600
    s_add_u32 s50, s50, 0x26000
    v_cndmask_b32 v20, v20, v195, s[60:61]
    v_mul_f32 v20, 0x3b000000, v20
    v_mfma_f32_16x16x32_bf16 v[176:179], v[200:203], v[28:31], v[176:179]
    ds_read_b64_tr_b16 v[210:211], v19 offset:26112
    v_fma_f32 v22, -v21, v21, v20
    v_max_f32 v22, 0, v22
    v_add_f32 v22, 0x3727c5ac, v22
    v_mfma_f32_16x16x32_bf16 v[128:131], v[200:203], a[80:83], v[128:131]
    buffer_load_dwordx4 v5, s[12:15], s81 offen offset:3072 lds
    v_mfma_f32_16x16x32_bf16 v[132:135], v[200:203], a[84:87], v[132:135]
    ds_read_b64 v[50:51], v25 offset:2048
    v_rsq_f32 v22, v22
    v_lshl_add_u32 v26, v14, 2, s50
    v_mfma_f32_16x16x32_bf16 v[136:139], v[200:203], a[88:91], v[136:139]
    ds_read_b64 v[52:53], v25 offset:4096
    v_lshl_add_u32 v27, v15, 4, s50
    v_mfma_f32_16x16x32_bf16 v[140:143], v[200:203], a[92:95], v[140:143]
    s_waitcnt lgkmcnt(6)
    ds_read_b64 v[54:55], v25 offset:6144
    ds_read_b64_tr_b16 v[126:127], v91 offset:24
    v_mfma_f32_16x16x32_bf16 v[176:179], v[204:207], v[28:31], v[176:179]
    s_mov_b64 exec, s[54:55]
    ds_write2st64_b32 v26, v21, v22 offset0:0 offset1:1
    s_mov_b64 exec, -1
    v_mfma_f32_16x16x32_bf16 v[128:131], v[204:207], a[96:99], v[128:131]
    v_readfirstlane_b32 s88, v16
    s_add_u32 s88, s88, 0x11111111
    v_mfma_f32_16x16x32_bf16 v[132:135], v[204:207], a[100:103], v[132:135]
    s_xor_b32 s88, s88, 0x9e3779b1
    v_mov_b32 v16, s88
    v_mfma_f32_16x16x32_bf16 v[136:139], v[204:207], a[104:107], v[136:139]
    s_waitcnt vmcnt(11)
    s_waitcnt lgkmcnt(0)
    s_barrier
    v_mfma_f32_16x16x32_bf16 v[140:143], v[204:207], a[108:111], v[140:143]
    ds_read_b64_tr_b16 v[196:197], v19 offset:32768
    s_add_u32 m0, s63, 0xfc00
    v_mfma_f32_16x16x32_bf16 v[176:179], v[208:211], v[28:31], v[176:179]
    ds_read_b64_tr_b16 v[198:199], v19 offset:33280
    v_lshlrev_b32 v41, 1, v0
    v_mfma_f32_16x16x32_bf16 v[128:131], v[208:211], a[112:115], v[128:131]
    ds_read_b64_tr_b16 v[200:201], v19 offset:40960
    v_lshrrev_b32 v41, v41, v16
    v_mfma_f32_16x16x32_bf16 v[132:135], v[208:211], a[116:119], v[132:135]
    ds_read_b64_tr_b16 v[202:203], v19 offset:41472
    s_mov_b32 s1, 0x30003
    v_mfma_f32_16x16x32_bf16 v[136:139], v[208:211], a[120:123], v[136:139]
    buffer_load_dwordx4 v4, s[12:15], s82 offen offset:1024 lds
    v_mfma_f32_16x16x32_bf16 v[140:143], v[208:211], a[124:127], v[140:143]
    s_waitcnt lgkmcnt(2)
    ds_read_b64_tr_b16 v[204:205], v19 offset:33792
    s_andn2_b32 s48, 3, s88
    v_mfma_f32_16x16x32_bf16 v[176:179], v[196:199], v[28:31], v[176:179]
    ds_read_b64_tr_b16 v[206:207], v19 offset:34304
    v_and_b32 v41, 3, v41
    v_mfma_f32_16x16x32_bf16 v[128:131], v[196:199], a[128:131], v[128:131]
    buffer_load_dwordx4 v5, s[12:15], s82 offen offset:3072 lds
    v_mfma_f32_16x16x32_bf16 v[132:135], v[196:199], a[132:135], v[132:135]
    s_add_u32 m0, s63, 0x10000
    ds_read_b32 v244, v26
    v_mfma_f32_16x16x32_bf16 v[136:139], v[196:199], a[136:139], v[136:139]
    buffer_load_dwordx4 v4, s[12:15], s83 offen offset:1024 lds
    v_mfma_f32_16x16x32_bf16 v[140:143], v[196:199], a[140:143], v[140:143]
    s_waitcnt lgkmcnt(3)
    ds_read_b64_tr_b16 v[208:209], v19 offset:41984
    v_xor_b32 v20, 64, v26
    v_mfma_f32_16x16x32_bf16 v[176:179], v[200:203], v[28:31], v[176:179]
    ds_read_b64_tr_b16 v[210:211], v19 offset:42496
    v_xor_b32 v21, 0x80, v26
    v_mfma_f32_16x16x32_bf16 v[128:131], v[200:203], a[144:147], v[128:131]
    buffer_load_dwordx4 v5, s[12:15], s83 offen offset:3072 lds
    v_mfma_f32_16x16x32_bf16 v[132:135], v[200:203], a[148:151], v[132:135]
    v_xor_b32 v22, 0xc0, v26
    v_lshlrev_b32 v23, 6, v15
    v_mfma_f32_16x16x32_bf16 v[136:139], v[200:203], a[152:155], v[136:139]
    ds_read_b32 v245, v20
    v_lshl_or_b32 v41, v41, 16, s48
    v_mfma_f32_16x16x32_bf16 v[140:143], v[200:203], a[156:159], v[140:143]
    s_waitcnt lgkmcnt(4)
    ds_read_b32 v246, v21
    v_mfma_f32_16x16x32_bf16 v[176:179], v[204:207], v[28:31], v[176:179]
    ds_read_b32 v247, v22
    v_xor_b32 v23, v23, v26
    v_mfma_f32_16x16x32_bf16 v[128:131], v[204:207], a[160:163], v[128:131]
    ds_read_b32 v93, v23 offset:256
    v_mfma_f32_16x16x32_bf16 v[132:135], v[204:207], a[164:167], v[132:135]
    v_mfma_f32_16x16x32_bf16 v[136:139], v[204:207], a[168:171], v[136:139]
    s_waitcnt vmcnt(11)
    s_barrier
    v_mfma_f32_16x16x32_bf16 v[140:143], v[204:207], a[172:175], v[140:143]
    s_waitcnt lgkmcnt(4)
    ds_read_b64_tr_b16 v[196:197], v19 offset:49152
    s_add_u32 m0, s63, 0x13c00
    v_mfma_f32_16x16x32_bf16 v[176:179], v[208:211], v[28:31], v[176:179]
    ds_read_b64_tr_b16 v[198:199], v19 offset:49664
    v_mfma_f32_16x16x32_bf16 v[128:131], v[208:211], a[176:179], v[128:131]
    ds_read_b64_tr_b16 v[200:201], v19 offset:57344
    v_xor_b32 v76, 64, v27
    v_mfma_f32_16x16x32_bf16 v[132:135], v[208:211], a[180:183], v[132:135]
    ds_read_b64_tr_b16 v[202:203], v19 offset:57856
    v_xor_b32 v77, 0x80, v27
    v_mfma_f32_16x16x32_bf16 v[136:139], v[208:211], a[184:187], v[136:139]
    buffer_load_dwordx4 v4, s[12:15], s84 offen offset:1024 lds
    v_mfma_f32_16x16x32_bf16 v[140:143], v[208:211], a[188:191], v[140:143]
    s_waitcnt lgkmcnt(2)
    ds_read_b64_tr_b16 v[204:205], v19 offset:50176
    v_xor_b32 v78, 0xc0, v27
    v_mfma_f32_16x16x32_bf16 v[176:179], v[196:199], v[28:31], v[176:179]
    ds_read_b64_tr_b16 v[206:207], v19 offset:50688
    v_mfma_f32_16x16x32_bf16 v[128:131], v[196:199], a[192:195], v[128:131]
    ds_read_b64_tr_b16 v[208:209], v19 offset:58368
    v_mfma_f32_16x16x32_bf16 v[132:135], v[196:199], a[196:199], v[132:135]
    ds_read_b64_tr_b16 v[210:211], v19 offset:58880
    v_mfma_f32_16x16x32_bf16 v[136:139], v[196:199], a[200:203], v[136:139]
    buffer_load_dwordx4 v5, s[12:15], s84 offen offset:3072 lds
    v_mfma_f32_16x16x32_bf16 v[140:143], v[196:199], a[204:207], v[140:143]
    s_waitcnt lgkmcnt(4)
    s_add_u32 m0, s63, 0x14000
    v_mfma_f32_16x16x32_bf16 v[176:179], v[200:203], v[28:31], v[176:179]
    buffer_load_dwordx4 v4, s[12:15], s85 offen offset:1024 lds
    v_mfma_f32_16x16x32_bf16 v[128:131], v[200:203], a[208:211], v[128:131]
    buffer_load_dwordx4 v5, s[12:15], s85 offen offset:3072 lds
    v_mfma_f32_16x16x32_bf16 v[132:135], v[200:203], a[212:215], v[132:135]
    v_cmp_eq_u32 vcc, 0, v14
    s_nop 1
    v_cndmask_b32 v188, 0, v28, vcc
    v_mfma_f32_16x16x32_bf16 v[136:139], v[200:203], a[216:219], v[136:139]
    v_mov_b32 v189, v188
    v_mov_b32 v190, v188
    v_mfma_f32_16x16x32_bf16 v[140:143], v[200:203], a[220:223], v[140:143]
    s_waitcnt lgkmcnt(2)
    v_mov_b32 v191, v188
    v_mfma_f32_16x16x32_bf16 v[176:179], v[204:207], v[28:31], v[176:179]
    s_waitcnt lgkmcnt(0)
    v_cmp_eq_u32 vcc, 1, v14
    s_nop 1
    v_cndmask_b32 v192, 0, v28, vcc
    v_mfma_f32_16x16x32_bf16 v[176:179], v[208:211], v[28:31], v[176:179]
    v_mov_b32 v193, v192
    v_mov_b32 v194, v192
    v_mfma_f32_16x16x32_bf16 v[128:131], v[204:207], a[224:227], v[128:131]
    v_mov_b32 v195, v192
    v_mul_f32 v93, 0x3fb8aa3b, v93
    v_mfma_f32_16x16x32_bf16 v[128:131], v[208:211], a[240:243], v[128:131]
    s_waitcnt vmcnt(8)
    s_barrier
    v_mfma_f32_16x16x32_bf16 v[132:135], v[204:207], a[228:231], v[132:135]
    ds_read_b64_tr_b16 v[196:197], v85 offset:0
    s_add_u32 m0, s63, 0x17c00
    v_mfma_f32_16x16x32_bf16 v[132:135], v[208:211], a[244:247], v[132:135]
    ds_read_b64_tr_b16 v[198:199], v85 offset:512
    s_nop 0
    v_fmac_f32 v128, v176, v244
    v_fmac_f32 v129, v177, v244
    v_mfma_f32_16x16x32_bf16 v[136:139], v[204:207], a[232:235], v[136:139]
    buffer_load_dwordx4 v4, s[12:15], s86 offen offset:1024 lds
    v_mfma_f32_16x16x32_bf16 v[136:139], v[208:211], a[248:251], v[136:139]
    ds_read_b64_tr_b16 v[200:201], v85 offset:8192
    v_fmac_f32 v130, v178, v244
    v_fmac_f32 v131, v179, v244
    v_fmac_f32 v132, v176, v245
    v_fmac_f32 v133, v177, v245
    v_mfma_f32_16x16x32_bf16 v[140:143], v[204:207], a[236:239], v[140:143]
    ds_read_b64_tr_b16 v[202:203], v85 offset:8704
    v_cvt_pk_bf16_f32 v248, v128, v129
    v_cvt_pk_bf16_f32 v249, v130, v131
    v_fmac_f32 v134, v178, v245
    v_fmac_f32 v135, v179, v245
    v_mfma_f32_16x16x32_bf16 v[140:143], v[208:211], a[252:255], v[140:143]
    buffer_load_dwordx4 v5, s[12:15], s86 offen offset:3072 lds
    v_cvt_pk_bf16_f32 v250, v132, v133
    v_cvt_pk_bf16_f32 v251, v134, v135
    s_nop 1
    v_mfma_f32_16x16x32_bf16 v[212:215], v[96:99], v[248:251], 0
    s_add_u32 m0, s63, 0x18000
    v_fmac_f32 v136, v176, v246
    v_fmac_f32 v137, v177, v246
    v_mfma_f32_16x16x32_bf16 v[216:219], v[104:107], v[248:251], 0
    buffer_load_dwordx4 v4, s[12:15], s87 offen offset:1024 lds
    v_fmac_f32 v140, v176, v247
    v_mfma_f32_16x16x32_bf16 v[220:223], v[112:115], v[248:251], 0
    buffer_load_dwordx4 v5, s[12:15], s87 offen offset:3072 lds
    v_fmac_f32 v141, v177, v247
    v_mfma_f32_16x16x32_bf16 v[224:227], v[120:123], v[248:251], 0
    s_waitcnt lgkmcnt(2)
    v_subrev_u32 v4, 0x400, v4
    v_subrev_u32 v5, 0x400, v5
    s_add_u32 m0, s63, 0
    v_fmac_f32 v142, v178, v247
    v_mfma_f32_16x16x32_bf16 v[180:183], v[28:31], v[196:199], 0
    buffer_load_dwordx4 v4, s[12:15], s80 offen offset:0 lds
    v_fmac_f32 v138, v178, v246
    v_fmac_f32 v143, v179, v247
    v_mfma_f32_16x16x32_bf16 v[144:147], a[0:3], v[196:199], 0
    buffer_load_dwordx4 v5, s[12:15], s80 offen offset:2048 lds
    s_add_u32 m0, s63, 0x400
    v_cvt_pk_bf16_f32 v254, v140, v141
    v_mfma_f32_16x16x32_bf16 v[148:151], a[4:7], v[196:199], 0
    buffer_load_dwordx4 v4, s[12:15], s81 offen offset:0 lds
    v_fmac_f32 v139, v179, v246
    v_cvt_pk_bf16_f32 v255, v142, v143
    v_mfma_f32_16x16x32_bf16 v[152:155], a[8:11], v[196:199], 0
    buffer_load_dwordx4 v5, s[12:15], s81 offen offset:2048 lds
    v_cvt_pk_bf16_f32 v252, v136, v137
    v_mfma_f32_16x16x32_bf16 v[156:159], a[12:15], v[196:199], 0
    s_add_u32 m0, s63, 0x4000
    v_cvt_pk_bf16_f32 v253, v138, v139
    s_nop 1
    v_mfma_f32_16x16x32_bf16 v[212:215], v[100:103], v[252:255], v[212:215]
    ds_read_b64_tr_b16 v[204:205], v85 offset:1024
    v_mfma_f32_16x16x32_bf16 v[216:219], v[108:111], v[252:255], v[216:219]
    ds_read_b64_tr_b16 v[206:207], v85 offset:1536
    v_mfma_f32_16x16x32_bf16 v[220:223], v[116:119], v[252:255], v[220:223]
    buffer_load_dwordx4 v4, s[12:15], s82 offen offset:0 lds
    v_mfma_f32_16x16x32_bf16 v[224:227], v[124:127], v[252:255], v[224:227]
    s_waitcnt lgkmcnt(2)
    buffer_load_dwordx4 v5, s[12:15], s82 offen offset:2048 lds
    v_mfma_f32_16x16x32_bf16 v[180:183], v[28:31], v[200:203], v[180:183]
    v_mfma_f32_16x16x32_bf16 v[144:147], a[16:19], v[200:203], v[144:147]
    ds_read_b64_tr_b16 v[208:209], v85 offset:9216
    v_max3_f32 v20, v212, v213, v214
    v_min3_f32 v21, v212, v213, v214
    v_max3_f32 v20, v20, v215, v216
    v_min3_f32 v21, v21, v215, v216
    v_mfma_f32_16x16x32_bf16 v[148:151], a[20:23], v[200:203], v[148:151]
    ds_read_b64_tr_b16 v[210:211], v85 offset:9728
    v_max3_f32 v20, v20, v217, v218
    v_min3_f32 v21, v21, v217, v218
    v_max3_f32 v20, v20, v219, v220
    v_min3_f32 v21, v21, v219, v220
    v_mfma_f32_16x16x32_bf16 v[152:155], a[24:27], v[200:203], v[152:155]
    v_max3_f32 v20, v20, v221, v222
    v_min3_f32 v21, v21, v221, v222
    v_max3_f32 v20, v20, v223, v224
    v_min3_f32 v21, v21, v223, v224
    v_max3_f32 v20, v20, v225, v226
    v_mfma_f32_16x16x32_bf16 v[156:159], a[28:31], v[200:203], v[156:159]
    s_waitcnt lgkmcnt(2)
    v_min3_f32 v21, v21, v225, v226
    v_max_f32 v20, v20, v227
    v_min_f32 v21, v21, v227
    v_mul_f32 v20, v20, v93
    v_mul_f32 v21, v21, v93
    v_mfma_f32_16x16x32_bf16 v[180:183], v[28:31], v[204:207], v[180:183]
    s_waitcnt vmcnt(14)
    s_barrier
    v_fma_f32 v228, v212, -v93, v21
    v_fma_f32 v229, v213, -v93, v21
    v_mfma_f32_16x16x32_bf16 v[144:147], a[32:35], v[204:207], v[144:147]
    ds_read_b64_tr_b16 v[196:197], v19 offset:0
    s_add_u32 m0, s63, 0x4400
    v_fma_f32 v212, v212, v93, -v20
    v_fma_f32 v213, v213, v93, -v20
    v_fma_f32 v230, v214, -v93, v21
    v_mfma_f32_16x16x32_bf16 v[148:151], a[36:39], v[204:207], v[148:151]
    ds_read_b64_tr_b16 v[198:199], v19 offset:512
    v_exp_f32 v228, v228
    v_fma_f32 v231, v215, -v93, v21
    v_fma_f32 v214, v214, v93, -v20
    v_mfma_f32_16x16x32_bf16 v[152:155], a[40:43], v[204:207], v[152:155]
    buffer_load_dwordx4 v4, s[12:15], s83 offen offset:0 lds
    v_exp_f32 v229, v229
    v_fma_f32 v215, v215, v93, -v20
    v_mfma_f32_16x16x32_bf16 v[156:159], a[44:47], v[204:207], v[156:159]
    s_waitcnt lgkmcnt(2)
    buffer_load_dwordx4 v5, s[12:15], s83 offen offset:2048 lds
    v_exp_f32 v212, v212
    v_mfma_f32_16x16x32_bf16 v[180:183], v[28:31], v[208:211], v[180:183]
    s_add_u32 m0, s63, 0x8000
    v_exp_f32 v213, v213
    v_exp_f32 v230, v230
    v_fma_f32 v232, v216, -v93, v21
    v_mfma_f32_16x16x32_bf16 v[144:147], a[48:51], v[208:211], v[144:147]
    ds_read_b64_tr_b16 v[200:201], v19 offset:8192
    v_fma_f32 v233, v217, -v93, v21
    v_exp_f32 v231, v231
    v_fma_f32 v216, v216, v93, -v20
    v_mfma_f32_16x16x32_bf16 v[148:151], a[52:55], v[208:211], v[148:151]
    ds_read_b64_tr_b16 v[202:203], v19 offset:8704
    v_fma_f32 v217, v217, v93, -v20
    v_exp_f32 v214, v214
    v_fma_f32 v234, v218, -v93, v21
    v_mfma_f32_16x16x32_bf16 v[152:155], a[56:59], v[208:211], v[152:155]
    buffer_load_dwordx4 v4, s[12:15], s84 offen offset:0 lds
    v_exp_f32 v215, v215
    v_fma_f32 v235, v219, -v93, v21
    v_mfma_f32_16x16x32_bf16 v[156:159], a[60:63], v[208:211], v[156:159]
    s_waitcnt lgkmcnt(2)
    buffer_load_dwordx4 v5, s[12:15], s84 offen offset:2048 lds
    v_exp_f32 v232, v232
    v_mfma_f32_16x16x32_bf16 v[180:183], v[28:31], v[196:199], v[180:183]
    s_add_u32 m0, s63, 0x8400
    s_nop 0
    buffer_load_dwordx4 v4, s[12:15], s85 offen offset:0 lds
    v_exp_f32 v233, v233
    v_mfma_f32_16x16x32_bf16 v[144:147], a[64:67], v[196:199], v[144:147]
    ds_read_b64_tr_b16 v[204:205], v19 offset:1024
    v_fma_f32 v218, v218, v93, -v20
    v_fma_f32 v219, v219, v93, -v20
    v_exp_f32 v216, v216
    v_mfma_f32_16x16x32_bf16 v[148:151], a[68:71], v[196:199], v[148:151]
    ds_read_b64_tr_b16 v[206:207], v19 offset:1536
    v_add_f32 v24, v228, v230
    v_add_f32 v25, v229, v231
    v_exp_f32 v217, v217
    v_mfma_f32_16x16x32_bf16 v[152:155], a[72:75], v[196:199], v[152:155]
    buffer_load_dwordx4 v5, s[12:15], s85 offen offset:2048 lds
    s_add_u32 m0, s63, 0xc000
    v_add_f32 v22, v212, v214
    v_add_f32 v23, v213, v215
    v_mfma_f32_16x16x32_bf16 v[156:159], a[76:79], v[196:199], v[156:159]
    s_waitcnt lgkmcnt(2)
    v_exp_f32 v234, v234
    v_fma_f32 v236, v220, -v93, v21
    v_fma_f32 v237, v221, -v93, v21
    v_fma_f32 v220, v220, v93, -v20
    v_mfma_f32_16x16x32_bf16 v[180:183], v[28:31], v[200:203], v[180:183]
    buffer_load_dwordx4 v4, s[12:15], s86 offen offset:0 lds
    v_exp_f32 v235, v235
    v_fma_f32 v221, v221, v93, -v20
    v_mfma_f32_16x16x32_bf16 v[144:147], a[80:83], v[200:203], v[144:147]
    ds_read_b64_tr_b16 v[208:209], v19 offset:9216
    v_exp_f32 v218, v218
    v_add_f32 v24, v24, v232
    v_add_f32 v25, v25, v233
    v_mfma_f32_16x16x32_bf16 v[148:151], a[84:87], v[200:203], v[148:151]
    ds_read_b64_tr_b16 v[210:211], v19 offset:9728
    v_exp_f32 v219, v219
    v_add_f32 v22, v22, v216
    v_add_f32 v23, v23, v217
    v_mfma_f32_16x16x32_bf16 v[152:155], a[88:91], v[200:203], v[152:155]
    buffer_load_dwordx4 v5, s[12:15], s86 offen offset:2048 lds
    v_exp_f32 v236, v236
    v_fma_f32 v238, v222, -v93, v21
    v_mfma_f32_16x16x32_bf16 v[156:159], a[92:95], v[200:203], v[156:159]
    s_waitcnt lgkmcnt(2)
    v_subrev_u32 v85, 0x10000, v19
    v_fma_f32 v239, v223, -v93, v21
    v_exp_f32 v237, v237
    v_fma_f32 v222, v222, v93, -v20
    v_mfma_f32_16x16x32_bf16 v[180:183], v[28:31], v[204:207], v[180:183]
    s_waitcnt vmcnt(18)
    s_barrier
    v_fma_f32 v223, v223, v93, -v20
    v_add_f32 v24, v24, v234
    v_mfma_f32_16x16x32_bf16 v[144:147], a[96:99], v[204:207], v[144:147]
    ds_read_b64_tr_b16 v[196:197], v19 offset:16384
    s_add_u32 m0, s63, 0xc400
    v_exp_f32 v220, v220
    v_add_f32 v25, v25, v235
    v_mfma_f32_16x16x32_bf16 v[148:151], a[100:103], v[204:207], v[148:151]
    ds_read_b64_tr_b16 v[198:199], v19 offset:16896
    v_exp_f32 v221, v221
    v_add_f32 v22, v22, v218
    v_add_f32 v23, v23, v219
    v_mfma_f32_16x16x32_bf16 v[152:155], a[104:107], v[204:207], v[152:155]
    buffer_load_dwordx4 v4, s[12:15], s87 offen offset:0 lds
    v_exp_f32 v238, v238
    v_fma_f32 v240, v224, -v93, v21
    v_mfma_f32_16x16x32_bf16 v[156:159], a[108:111], v[204:207], v[156:159]
    s_waitcnt lgkmcnt(2)
    v_fma_f32 v241, v225, -v93, v21
    v_exp_f32 v239, v239
    v_fma_f32 v224, v224, v93, -v20
    v_fma_f32 v225, v225, v93, -v20
    v_mfma_f32_16x16x32_bf16 v[180:183], v[28:31], v[208:211], v[180:183]
    buffer_load_dwordx4 v5, s[12:15], s87 offen offset:2048 lds
    v_exp_f32 v222, v222
    v_add_f32 v24, v24, v236
    v_mfma_f32_16x16x32_bf16 v[144:147], a[112:115], v[208:211], v[144:147]
    ds_read_b64_tr_b16 v[200:201], v19 offset:24576
    v_add_f32 v25, v25, v237
    v_exp_f32 v223, v223
    v_add_f32 v22, v22, v220
    v_mfma_f32_16x16x32_bf16 v[148:151], a[116:119], v[208:211], v[148:151]
    ds_read_b64_tr_b16 v[202:203], v19 offset:25088
    v_add_f32 v23, v23, v221
    v_exp_f32 v240, v240
    v_fma_f32 v242, v226, -v93, v21
    v_mfma_f32_16x16x32_bf16 v[152:155], a[120:123], v[208:211], v[152:155]
    s_lshl_b32 s68, s97, 12
    v_fma_f32 v243, v227, -v93, v21
    v_exp_f32 v241, v241
    v_fma_f32 v226, v226, v93, -v20
    v_fma_f32 v227, v227, v93, -v20
    v_mfma_f32_16x16x32_bf16 v[156:159], a[124:127], v[208:211], v[156:159]
    s_waitcnt lgkmcnt(2)
    ds_read_b128 v[128:131], v27
    v_exp_f32 v224, v224
    v_add_f32 v24, v24, v238
    v_add_f32 v25, v25, v239
    v_mfma_f32_16x16x32_bf16 v[180:183], v[28:31], v[196:199], v[180:183]
    ds_read_b128 v[56:59], v27 offset:256
    v_lshlrev_b32 v68, 7, v0
    v_exp_f32 v225, v225
    v_add_f32 v22, v22, v222
    v_mfma_f32_16x16x32_bf16 v[144:147], a[128:131], v[196:199], v[144:147]
    ds_read_b64_tr_b16 v[204:205], v19 offset:17408
    v_add_f32 v23, v23, v223
    v_exp_f32 v242, v242
    v_add_f32 v24, v24, v240
    v_mfma_f32_16x16x32_bf16 v[148:151], a[132:135], v[196:199], v[148:151]
    ds_read_b64_tr_b16 v[206:207], v19 offset:17920
    v_add_f32 v25, v25, v241
    v_exp_f32 v243, v243
    v_add_f32 v22, v22, v224
    v_mfma_f32_16x16x32_bf16 v[152:155], a[136:139], v[196:199], v[152:155]
    s_mov_b64 exec, -1
    s_mov_b32 exec_hi, 0
    buffer_load_dword v69, v68, s[20:23], s68 offen
    s_mov_b64 exec, -1
    v_mfma_f32_16x16x32_bf16 v[156:159], a[140:143], v[196:199], v[156:159]
    s_waitcnt lgkmcnt(4)
    ds_read_b128 v[132:135], v76
    v_add_f32 v23, v23, v225
    v_exp_f32 v226, v226
    v_add_f32 v24, v24, v242
    v_mfma_f32_16x16x32_bf16 v[180:183], v[28:31], v[200:203], v[180:183]
    s_lshl_b32 s69, s2, 2
    s_add_u32 s69, s69, s3
    v_lshlrev_b32 v68, 7, v0
    s_lshr_b32 s68, s69, 1
    s_mul_i32 s68, s68, 0xb00
    s_mov_b64 exec, 0x3fffff
    buffer_load_dword v69, v68, s[24:27], s68 offen
    s_mov_b64 exec, -1
    v_mfma_f32_16x16x32_bf16 v[144:147], a[144:147], v[200:203], v[144:147]
    ds_read_b64_tr_b16 v[208:209], v19 offset:25600
    v_exp_f32 v227, v227
    v_add_f32 v25, v25, v243
    v_add_f32 v22, v22, v226
    v_mfma_f32_16x16x32_bf16 v[148:151], a[148:151], v[200:203], v[148:151]
    ds_read_b64_tr_b16 v[210:211], v19 offset:26112
    v_add_f32 v23, v23, v227
    v_add_f32 v24, v24, v25
    v_add_f32 v22, v22, v23
    v_mfma_f32_16x16x32_bf16 v[152:155], a[152:155], v[200:203], v[152:155]
    ds_read_b128 v[60:63], v76 offset:256
    v_rcp_f32 v24, v24
    v_rcp_f32 v22, v22
    v_mfma_f32_16x16x32_bf16 v[156:159], a[156:159], v[200:203], v[156:159]
    s_waitcnt lgkmcnt(4)
    ds_read_b128 v[136:139], v77
    v_mul_f32 v228, v228, v24
    v_mul_f32 v229, v229, v24
    v_mul_f32 v212, v212, v22
    v_mul_f32 v213, v213, v22
    v_mfma_f32_16x16x32_bf16 v[180:183], v[28:31], v[204:207], v[180:183]
    s_waitcnt vmcnt(18)
    s_barrier
    v_mul_f32 v230, v230, v24
    v_mul_f32 v231, v231, v24
    v_mfma_f32_16x16x32_bf16 v[144:147], a[160:163], v[204:207], v[144:147]
    ds_read_b64_tr_b16 v[196:197], v19 offset:32768
    v_mul_f32 v214, v214, v22
    v_mul_f32 v215, v215, v22
    v_cvt_pk_bf16_f32 v212, v212, v213
    v_cvt_pk_bf16_f32 v213, v214, v215
    v_mfma_f32_16x16x32_bf16 v[148:151], a[164:167], v[204:207], v[148:151]
    ds_read_b64_tr_b16 v[198:199], v19 offset:33280
    v_cvt_pk_bf16_f32 v214, v228, v229
    v_cvt_pk_bf16_f32 v215, v230, v231
    v_mul_f32 v232, v232, v24
    v_mul_f32 v233, v233, v24
    v_mfma_f32_16x16x32_bf16 v[152:155], a[168:171], v[204:207], v[152:155]
    ds_read_b128 v[64:67], v77 offset:256
    v_mul_f32 v216, v216, v22
    v_mul_f32 v217, v217, v22
    v_mul_f32 v234, v234, v24
    v_mul_f32 v235, v235, v24
    v_mfma_f32_16x16x32_bf16 v[156:159], a[172:175], v[204:207], v[156:159]
    s_waitcnt lgkmcnt(5)
    ds_read_b128 v[140:143], v78
    v_mul_f32 v218, v218, v22
    v_mul_f32 v219, v219, v22
    v_cvt_pk_bf16_f32 v216, v216, v217
    v_cvt_pk_bf16_f32 v217, v218, v219
    v_mfma_f32_16x16x32_bf16 v[180:183], v[28:31], v[208:211], v[180:183]
    ds_read_b128 v[72:75], v78 offset:256
    v_cvt_pk_bf16_f32 v218, v232, v233
    v_cvt_pk_bf16_f32 v219, v234, v235
    v_mul_f32 v236, v236, v24
    v_mul_f32 v237, v237, v24
    v_mfma_f32_16x16x32_bf16 v[144:147], a[176:179], v[208:211], v[144:147]
    ds_read_b64_tr_b16 v[200:201], v19 offset:40960
    v_mul_f32 v220, v220, v22
    v_mul_f32 v221, v221, v22
    v_mul_f32 v238, v238, v24
    v_mul_f32 v239, v239, v24
    v_mfma_f32_16x16x32_bf16 v[148:151], a[180:183], v[208:211], v[148:151]
    ds_read_b64_tr_b16 v[202:203], v19 offset:41472
    v_mul_f32 v222, v222, v22
    v_mul_f32 v223, v223, v22
    v_cvt_pk_bf16_f32 v220, v220, v221
    v_cvt_pk_bf16_f32 v221, v222, v223
    v_mfma_f32_16x16x32_bf16 v[152:155], a[184:187], v[208:211], v[152:155]
    ds_read_b64_tr_b16 v[204:205], v19 offset:33792
    v_cvt_pk_bf16_f32 v222, v236, v237
    v_cvt_pk_bf16_f32 v223, v238, v239
    v_mul_f32 v240, v240, v24
    v_mul_f32 v241, v241, v24
    v_mfma_f32_16x16x32_bf16 v[156:159], a[188:191], v[208:211], v[156:159]
    s_waitcnt lgkmcnt(6)
    ds_read_b64_tr_b16 v[206:207], v19 offset:34304
    v_mul_f32 v224, v224, v22
    v_mul_f32 v225, v225, v22
    v_mul_f32 v242, v242, v24
    v_mul_f32 v243, v243, v24
    v_mfma_f32_16x16x32_bf16 v[180:183], v[28:31], v[196:199], v[180:183]
    ds_read_b64_tr_b16 v[208:209], v19 offset:41984
    v_mul_f32 v226, v226, v22
    v_mul_f32 v227, v227, v22
    v_cvt_pk_bf16_f32 v224, v224, v225
    v_cvt_pk_bf16_f32 v225, v226, v227
    v_mfma_f32_16x16x32_bf16 v[144:147], a[192:195], v[196:199], v[144:147]
    s_mul_i32 s53, s45, 0x11000
    ds_read_b64_tr_b16 v[210:211], v19 offset:42496
    v_cvt_pk_bf16_f32 v226, v240, v241
    v_cvt_pk_bf16_f32 v227, v242, v243
    v_mfma_f32_16x16x32_bf16 v[148:151], a[196:199], v[196:199], v[148:151]
    ds_write_b128 v82, v[212:215] offset:0
    v_mfma_f32_16x16x32_bf16 v[152:155], a[200:203], v[196:199], v[152:155]
    ds_write_b128 v82, v[216:219] offset:16
    v_mfma_f32_16x16x32_bf16 v[156:159], a[204:207], v[196:199], v[156:159]
    s_waitcnt lgkmcnt(6)
    ds_write_b128 v82, v[220:223] offset:32
    v_mfma_f32_16x16x32_bf16 v[180:183], v[28:31], v[200:203], v[180:183]
    s_waitcnt lgkmcnt(5)
    ds_write_b128 v82, v[224:227] offset:48
    v_mfma_f32_16x16x32_bf16 v[180:183], v[28:31], v[204:207], v[180:183]
    s_waitcnt lgkmcnt(4)
    ds_read_b64_tr_b16 v[228:229], v83 offset:0
    s_add_u32 s53, s53, 0x80000
    s_lshl_b32 s50, s4, 7
    v_mfma_f32_16x16x32_bf16 v[180:183], v[28:31], v[208:211], v[180:183]
    ds_read_b64_tr_b16 v[230:231], v83 offset:1280
    s_add_u32 s50, s50, s53
    s_add_u32 s51, s50, 0x8000
    v_mfma_f32_16x16x32_bf16 v[144:147], a[208:211], v[200:203], v[144:147]
    ds_read_b64_tr_b16 v[232:233], v83 offset:2560
    s_lshl_b32 s52, s4, 4
    s_add_u32 s52, s52, s53
    v_mfma_f32_16x16x32_bf16 v[144:147], a[224:227], v[204:207], v[144:147]
    ds_read_b64_tr_b16 v[234:235], v83 offset:3840
    s_add_u32 s52, s52, 0x10000
    s_bfe_u32 s61, s88, 0x80000
    v_mfma_f32_16x16x32_bf16 v[144:147], a[240:243], v[208:211], v[144:147]
    ds_read_b64_tr_b16 v[236:237], v83 offset:8
    s_bfe_u32 s89, s88, 0x80008
    s_bfe_u32 s90, s88, 0x80010
    v_mfma_f32_16x16x32_bf16 v[148:151], a[212:215], v[200:203], v[148:151]
    ds_read_b64_tr_b16 v[238:239], v83 offset:1288
    s_bfe_u32 s91, s88, 0x80018
    s_andn2_b32 s61, s61, 1
    v_mfma_f32_16x16x32_bf16 v[148:151], a[228:231], v[204:207], v[148:151]
    ds_read_b64_tr_b16 v[240:241], v83 offset:2568
    v_fmac_f32 v144, v128, v180
    v_mfma_f32_16x16x32_bf16 v[148:151], a[244:247], v[208:211], v[148:151]
    ds_read_b64_tr_b16 v[242:243], v83 offset:3848
    v_fmac_f32 v145, v129, v180
    v_mfma_f32_16x16x32_bf16 v[152:155], a[216:219], v[200:203], v[152:155]
    v_fmac_f32 v146, v130, v180
    v_fmac_f32 v147, v131, v180
    v_mfma_f32_16x16x32_bf16 v[152:155], a[232:235], v[204:207], v[152:155]
    v_mul_f32 v144, v144, v56
    v_mul_f32 v145, v145, v57
    v_fmac_f32 v148, v132, v180
    v_mfma_f32_16x16x32_bf16 v[152:155], a[248:251], v[208:211], v[152:155]
    v_mul_f32 v146, v146, v58
    v_mul_f32 v147, v147, v59
    v_fmac_f32 v149, v133, v180
    v_mfma_f32_16x16x32_bf16 v[156:159], a[220:223], v[200:203], v[156:159]
    v_cvt_pk_bf16_f32 v248, v144, v145
    v_cvt_pk_bf16_f32 v249, v146, v147
    v_fmac_f32 v150, v134, v180
    v_mfma_f32_16x16x32_bf16 v[156:159], a[236:239], v[204:207], v[156:159]
    s_waitcnt vmcnt(14)
    s_barrier
    v_mfma_f32_16x16x32_bf16 v[156:159], a[252:255], v[208:211], v[156:159]
    s_waitcnt lgkmcnt(6)
    ds_read_b64_tr_b16 v[196:197], v85 offset:0
    v_fmac_f32 v151, v135, v180
    v_mul_f32 v148, v148, v60
    v_mfma_f32_16x16x32_bf16 v[220:223], v[228:231], v[188:191], 0
    s_waitcnt lgkmcnt(5)
    ds_read_b64_tr_b16 v[198:199], v85 offset:512
    v_mul_f32 v149, v149, v61
    v_mul_f32 v150, v150, v62
    v_mfma_f32_16x16x32_bf16 v[220:223], v[232:235], v[188:191], v[220:223]
    s_waitcnt lgkmcnt(4)
    v_mul_f32 v151, v151, v63
    v_cvt_pk_bf16_f32 v250, v148, v149
    v_cvt_pk_bf16_f32 v251, v150, v151
    v_fmac_f32 v156, v140, v180
    v_fmac_f32 v157, v141, v180
    v_mfma_f32_16x16x32_bf16 v[220:223], v[236:239], v[192:195], v[220:223]
    s_waitcnt lgkmcnt(2)
    v_fmac_f32 v152, v136, v180
    v_fmac_f32 v153, v137, v180
    v_fmac_f32 v154, v138, v180
    v_fmac_f32 v158, v142, v180
    v_fmac_f32 v159, v143, v180
    v_mfma_f32_16x16x32_bf16 v[220:223], v[240:243], v[192:195], v[220:223]
    v_fmac_f32 v155, v139, v180
    v_mul_f32 v152, v152, v64
    v_mul_f32 v153, v153, v65
    v_mul_f32 v156, v156, v72
    v_mul_f32 v157, v157, v73
    v_mfma_f32_16x16x32_bf16 v[212:215], v[228:231], v[248:251], 0
    ds_read_b64_tr_b16 v[200:201], v85 offset:8192
    v_mul_f32 v154, v154, v66
    v_mul_f32 v155, v155, v67
    v_mul_f32 v158, v158, v74
    v_mul_f32 v159, v159, v75
    v_mfma_f32_16x16x32_bf16 v[216:219], v[236:239], v[248:251], 0
    ds_read_b64_tr_b16 v[202:203], v85 offset:8704
    v_cvt_pk_bf16_f32 v252, v152, v153
    v_cvt_pk_bf16_f32 v253, v154, v155
    v_cvt_pk_bf16_f32 v254, v156, v157
    v_cvt_pk_bf16_f32 v255, v158, v159
    s_nop 1
    v_mfma_f32_16x16x32_bf16 v[212:215], v[232:235], v[252:255], v[212:215]
    v_mfma_f32_16x16x32_bf16 v[216:219], v[240:243], v[252:255], v[216:219]
    s_waitcnt lgkmcnt(2)
    v_bfi_b32 v220, v87, s61, v220
    v_bfi_b32 v221, v87, s89, v221
    v_bfi_b32 v222, v87, s90, v222
    v_mfma_f32_16x16x32_bf16 v[184:187], v[196:199], v[28:31], 0
    v_bfi_b32 v223, v87, s91, v223
    buffer_store_dwordx4 v[220:223], v81, s[40:43], s52 offen sc1
    v_bfi_b32 v212, v87, s61, v212
    v_bfi_b32 v213, v87, s89, v213
    v_bfi_b32 v214, v87, s90, v214
    v_bfi_b32 v215, v87, s91, v215
    v_mfma_f32_16x16x32_bf16 v[160:163], v[196:199], a[0:3], 0
    ds_read_b64_tr_b16 v[204:205], v85 offset:1024
    buffer_store_dwordx4 v[212:215], v80, s[40:43], s50 offen sc1
    v_bfi_b32 v216, v87, s61, v216
    v_bfi_b32 v217, v87, s89, v217
    v_bfi_b32 v218, v87, s90, v218
    v_bfi_b32 v219, v87, s91, v219
    v_mfma_f32_16x16x32_bf16 v[164:167], v[196:199], a[4:7], 0
    ds_read_b64_tr_b16 v[206:207], v85 offset:1536
    buffer_store_dwordx4 v[216:219], v80, s[40:43], s51 offen sc1
    v_mfma_f32_16x16x32_bf16 v[168:171], v[196:199], a[8:11], 0
    v_mfma_f32_16x16x32_bf16 v[172:175], v[196:199], a[12:15], 0
    s_waitcnt lgkmcnt(2)
    v_mfma_f32_16x16x32_bf16 v[184:187], v[200:203], v[28:31], v[184:187]
    v_mfma_f32_16x16x32_bf16 v[160:163], v[200:203], a[16:19], v[160:163]
    ds_read_b64_tr_b16 v[208:209], v85 offset:9216
    v_mfma_f32_16x16x32_bf16 v[164:167], v[200:203], a[20:23], v[164:167]
    ds_read_b64_tr_b16 v[210:211], v85 offset:9728
    v_mfma_f32_16x16x32_bf16 v[168:171], v[200:203], a[24:27], v[168:171]
    v_mfma_f32_16x16x32_bf16 v[172:175], v[200:203], a[28:31], v[172:175]
    s_waitcnt lgkmcnt(2)
    v_mfma_f32_16x16x32_bf16 v[184:187], v[204:207], v[28:31], v[184:187]
    s_waitcnt vmcnt(13)
    s_barrier
    v_mfma_f32_16x16x32_bf16 v[160:163], v[204:207], a[32:35], v[160:163]
    ds_read_b64_tr_b16 v[196:197], v85 offset:16384
    s_and_b32 s86, s3, 1
    v_mfma_f32_16x16x32_bf16 v[164:167], v[204:207], a[36:39], v[164:167]
    ds_read_b64_tr_b16 v[198:199], v85 offset:16896
    v_bfe_u32 v42, v0, 4, 1
    v_mfma_f32_16x16x32_bf16 v[168:171], v[204:207], a[40:43], v[168:171]
    v_xor_b32 v42, s86, v42
    v_and_b32 v2, 0x1ff, v18
    v_mfma_f32_16x16x32_bf16 v[172:175], v[204:207], a[44:47], v[172:175]
    s_waitcnt lgkmcnt(2)
    v_lshl_add_u32 v42, v42, 9, v2
    s_add_u32 s86, s86, s0
    v_mfma_f32_16x16x32_bf16 v[184:187], v[208:211], v[28:31], v[184:187]
    s_and_b32 s86, s86, 3
    s_lshl_b32 s86, s86, 12
    s_lshl_b32 s92, s6, 17
    v_mfma_f32_16x16x32_bf16 v[160:163], v[208:211], a[48:51], v[160:163]
    ds_read_b64_tr_b16 v[200:201], v85 offset:24576
    s_add_u32 s92, s92, s86
    v_mfma_f32_16x16x32_bf16 v[164:167], v[208:211], a[52:55], v[164:167]
    ds_read_b64_tr_b16 v[202:203], v85 offset:25088
    s_lshr_b32 s86, s3, 1
    v_mfma_f32_16x16x32_bf16 v[168:171], v[208:211], a[56:59], v[168:171]
    s_lshl_b32 s87, s86, 16
    s_add_u32 s92, s92, s87
    s_add_u32 s92, s92, 0x500000
    v_mfma_f32_16x16x32_bf16 v[172:175], v[208:211], a[60:63], v[172:175]
    s_waitcnt lgkmcnt(2)
    s_xor_b32 s58, s92, 0x2000
    v_lshrrev_b32 v2, 5, v0
    v_mfma_f32_16x16x32_bf16 v[184:187], v[196:199], v[28:31], v[184:187]
    s_mov_b32 s87, 0x10e00
    v_mad_u32_u24 v2, v2, s87, v1
    v_add_u32 v3, 0x200, v2
    v_mfma_f32_16x16x32_bf16 v[160:163], v[196:199], a[64:67], v[160:163]
    ds_read_b64_tr_b16 v[204:205], v85 offset:17408
    v_add_u32 v4, 0x400, v2
    v_mfma_f32_16x16x32_bf16 v[164:167], v[196:199], a[68:71], v[164:167]
    ds_read_b64_tr_b16 v[206:207], v85 offset:17920
    v_add_u32 v5, 0x600, v2
    v_mfma_f32_16x16x32_bf16 v[168:171], v[196:199], a[72:75], v[168:171]
    s_lshl_b32 s86, s86, 10
    s_add_u32 s86, s86, s53
    s_lshr_b32 s87, s4, 2
    v_mfma_f32_16x16x32_bf16 v[172:175], v[196:199], a[76:79], v[172:175]
    s_waitcnt lgkmcnt(2)
    s_lshl_b32 s87, s87, 13
    s_and_b32 s81, s4, 1
    v_mfma_f32_16x16x32_bf16 v[184:187], v[200:203], v[28:31], v[184:187]
    s_lshl_b32 s81, s81, 12
    s_add_u32 s87, s87, s81
    s_and_b32 s81, s4, 2
    v_mfma_f32_16x16x32_bf16 v[160:163], v[200:203], a[80:83], v[160:163]
    ds_read_b64_tr_b16 v[208:209], v85 offset:25600
    s_lshl_b32 s81, s81, 10
    v_mfma_f32_16x16x32_bf16 v[164:167], v[200:203], a[84:87], v[164:167]
    ds_read_b64_tr_b16 v[210:211], v85 offset:26112
    s_add_u32 s87, s87, s81
    v_mfma_f32_16x16x32_bf16 v[168:171], v[200:203], a[88:91], v[168:171]
    s_add_u32 s86, s86, s87
    s_mul_i32 s81, s3, 0x88000
    s_add_u32 s87, s87, s81
    v_mfma_f32_16x16x32_bf16 v[172:175], v[200:203], a[92:95], v[172:175]
    s_waitcnt lgkmcnt(2)
    s_add_u32 s81, s87, 0x80000
    s_add_u32 s82, s87, 0xa1c00
    v_mfma_f32_16x16x32_bf16 v[184:187], v[204:207], v[28:31], v[184:187]
    s_waitcnt vmcnt(9)
    s_barrier
    v_mfma_f32_16x16x32_bf16 v[160:163], v[204:207], a[96:99], v[160:163]
    ds_read_b64_tr_b16 v[196:197], v85 offset:32768
    s_add_u32 s83, s87, 0xc3800
    v_mfma_f32_16x16x32_bf16 v[164:167], v[204:207], a[100:103], v[164:167]
    ds_read_b64_tr_b16 v[198:199], v85 offset:33280
    s_add_u32 s84, s87, 0xe5400
    v_mfma_f32_16x16x32_bf16 v[168:171], v[204:207], a[104:107], v[168:171]
    s_xor_b32 s87, s86, 0x400
    s_mul_i32 s48, s3, 0x58000
    s_mov_b32 s96, 0x10002
    v_mfma_f32_16x16x32_bf16 v[172:175], v[204:207], a[108:111], v[172:175]
    s_waitcnt lgkmcnt(2)
    v_add_u32 v27, 0xc000, v1
    v_mfma_f32_16x16x32_bf16 v[184:187], v[208:211], v[28:31], v[184:187]
    v_mfma_f32_16x16x32_bf16 v[160:163], v[208:211], a[112:115], v[160:163]
    ds_read_b64_tr_b16 v[200:201], v85 offset:40960
    v_mfma_f32_16x16x32_bf16 v[164:167], v[208:211], a[116:119], v[164:167]
    ds_read_b64_tr_b16 v[202:203], v85 offset:41472
    v_mfma_f32_16x16x32_bf16 v[168:171], v[208:211], a[120:123], v[168:171]
    v_mfma_f32_16x16x32_bf16 v[172:175], v[208:211], a[124:127], v[172:175]
    s_waitcnt lgkmcnt(2)
    v_mfma_f32_16x16x32_bf16 v[184:187], v[196:199], v[28:31], v[184:187]
    v_mfma_f32_16x16x32_bf16 v[160:163], v[196:199], a[128:131], v[160:163]
    ds_read_b64_tr_b16 v[204:205], v85 offset:33792
    v_mfma_f32_16x16x32_bf16 v[164:167], v[196:199], a[132:135], v[164:167]
    ds_read_b64_tr_b16 v[206:207], v85 offset:34304
    v_mfma_f32_16x16x32_bf16 v[168:171], v[196:199], a[136:139], v[168:171]
    v_mfma_f32_16x16x32_bf16 v[172:175], v[196:199], a[140:143], v[172:175]
    s_waitcnt lgkmcnt(2)
    v_mfma_f32_16x16x32_bf16 v[184:187], v[200:203], v[28:31], v[184:187]
    v_mfma_f32_16x16x32_bf16 v[160:163], v[200:203], a[144:147], v[160:163]
    ds_read_b64_tr_b16 v[208:209], v85 offset:41984
    v_mfma_f32_16x16x32_bf16 v[164:167], v[200:203], a[148:151], v[164:167]
    ds_read_b64_tr_b16 v[210:211], v85 offset:42496
    v_mfma_f32_16x16x32_bf16 v[168:171], v[200:203], a[152:155], v[168:171]
    v_mfma_f32_16x16x32_bf16 v[172:175], v[200:203], a[156:159], v[172:175]
    s_waitcnt lgkmcnt(2)
    v_mfma_f32_16x16x32_bf16 v[184:187], v[204:207], v[28:31], v[184:187]
    s_waitcnt vmcnt(5)
    s_waitcnt lgkmcnt(0)
    s_barrier
    v_mfma_f32_16x16x32_bf16 v[160:163], v[204:207], a[160:163], v[160:163]
    ds_read_b64_tr_b16 v[196:197], v85 offset:49152
    v_mfma_f32_16x16x32_bf16 v[164:167], v[204:207], a[164:167], v[164:167]
    ds_read_b64_tr_b16 v[198:199], v85 offset:49664
    v_mfma_f32_16x16x32_bf16 v[168:171], v[204:207], a[168:171], v[168:171]
    v_mfma_f32_16x16x32_bf16 v[172:175], v[204:207], a[172:175], v[172:175]
    v_mfma_f32_16x16x32_bf16 v[184:187], v[208:211], v[28:31], v[184:187]
    v_mfma_f32_16x16x32_bf16 v[160:163], v[208:211], a[176:179], v[160:163]
    ds_read_b64_tr_b16 v[200:201], v85 offset:57344
    v_mfma_f32_16x16x32_bf16 v[164:167], v[208:211], a[180:183], v[164:167]
    ds_read_b64_tr_b16 v[202:203], v85 offset:57856
    v_mfma_f32_16x16x32_bf16 v[168:171], v[208:211], a[184:187], v[168:171]
    v_mfma_f32_16x16x32_bf16 v[172:175], v[208:211], a[188:191], v[172:175]
    s_waitcnt lgkmcnt(2)
    v_mfma_f32_16x16x32_bf16 v[184:187], v[196:199], v[28:31], v[184:187]
    v_mfma_f32_16x16x32_bf16 v[160:163], v[196:199], a[192:195], v[160:163]
    ds_read_b64_tr_b16 v[204:205], v85 offset:50176
    v_mfma_f32_16x16x32_bf16 v[164:167], v[196:199], a[196:199], v[164:167]
    ds_read_b64_tr_b16 v[206:207], v85 offset:50688
    v_mfma_f32_16x16x32_bf16 v[168:171], v[196:199], a[200:203], v[168:171]
    v_mfma_f32_16x16x32_bf16 v[172:175], v[196:199], a[204:207], v[172:175]
    s_waitcnt lgkmcnt(2)
    ds_read_b64_tr_b16 v[208:209], v85 offset:58368
    v_mfma_f32_16x16x32_bf16 v[184:187], v[200:203], v[28:31], v[184:187]
    ds_read_b64_tr_b16 v[210:211], v85 offset:58880
    v_mfma_f32_16x16x32_bf16 v[160:163], v[200:203], a[208:211], v[160:163]
    v_mfma_f32_16x16x32_bf16 v[164:167], v[200:203], a[212:215], v[164:167]
    v_mfma_f32_16x16x32_bf16 v[168:171], v[200:203], a[216:219], v[168:171]
    v_mfma_f32_16x16x32_bf16 v[172:175], v[200:203], a[220:223], v[172:175]
    s_waitcnt lgkmcnt(2)
    v_mfma_f32_16x16x32_bf16 v[184:187], v[204:207], v[28:31], v[184:187]
    s_waitcnt lgkmcnt(0)
    v_mfma_f32_16x16x32_bf16 v[184:187], v[208:211], v[28:31], v[184:187]
    v_mfma_f32_16x16x32_bf16 v[160:163], v[204:207], a[224:227], v[160:163]
    v_mfma_f32_16x16x32_bf16 v[160:163], v[208:211], a[240:243], v[160:163]
    v_mfma_f32_16x16x32_bf16 v[164:167], v[204:207], a[228:231], v[164:167]
    v_mfma_f32_16x16x32_bf16 v[164:167], v[208:211], a[244:247], v[164:167]
    s_nop 5
    v_fmac_f32 v160, v184, v244
    v_fmac_f32 v161, v185, v244
    v_mfma_f32_16x16x32_bf16 v[168:171], v[204:207], a[232:235], v[168:171]
    v_fmac_f32 v162, v186, v244
    v_fmac_f32 v163, v187, v244
    v_mfma_f32_16x16x32_bf16 v[168:171], v[208:211], a[248:251], v[168:171]
    v_cvt_pk_bf16_f32 v248, v160, v161
    v_cvt_pk_bf16_f32 v249, v162, v163
    v_fmac_f32 v164, v184, v245
    v_mfma_f32_16x16x32_bf16 v[172:175], v[204:207], a[236:239], v[172:175]
    v_fmac_f32 v165, v185, v245
    v_fmac_f32 v166, v186, v245
    v_fmac_f32 v167, v187, v245
    v_mfma_f32_16x16x32_bf16 v[172:175], v[208:211], a[252:255], v[172:175]
    v_cvt_pk_bf16_f32 v250, v164, v165
    v_cvt_pk_bf16_f32 v251, v166, v167
    s_nop 1
    v_mfma_f32_16x16x32_bf16 v[212:215], v[96:99], v[248:251], 0
    v_fmac_f32 v168, v184, v246
    v_fmac_f32 v169, v185, v246
    v_mfma_f32_16x16x32_bf16 v[216:219], v[104:107], v[248:251], 0
    v_fmac_f32 v170, v186, v246
    v_fmac_f32 v171, v187, v246
    v_fmac_f32 v172, v184, v247
    v_fmac_f32 v173, v185, v247
    v_mfma_f32_16x16x32_bf16 v[220:223], v[112:115], v[248:251], 0
    v_cvt_pk_bf16_f32 v252, v168, v169
    v_cvt_pk_bf16_f32 v253, v170, v171
    v_fmac_f32 v174, v186, v247
    v_fmac_f32 v175, v187, v247
    v_mfma_f32_16x16x32_bf16 v[224:227], v[120:123], v[248:251], 0
    v_cvt_pk_bf16_f32 v254, v172, v173
    v_cvt_pk_bf16_f32 v255, v174, v175
    s_nop 1
    v_mfma_f32_16x16x32_bf16 v[212:215], v[100:103], v[252:255], v[212:215]
    v_mfma_f32_16x16x32_bf16 v[216:219], v[108:111], v[252:255], v[216:219]
    v_mfma_f32_16x16x32_bf16 v[220:223], v[116:119], v[252:255], v[220:223]
    v_mfma_f32_16x16x32_bf16 v[224:227], v[124:127], v[252:255], v[224:227]
    s_add_u32 m0, s63, 0x10000
    s_add_u32 s65, s95, 0
    buffer_load_dwordx4 v6, s[20:23], s65 offen offset:0 lds
    buffer_load_dwordx4 v7, s[20:23], s65 offen offset:1024 lds
    buffer_load_dwordx4 v8, s[20:23], s65 offen offset:2048 lds
    buffer_load_dwordx4 v9, s[20:23], s65 offen offset:3072 lds
    s_add_u32 m0, s63, 0x14000
    s_add_u32 s65, s95, 0x20000
    buffer_load_dwordx4 v6, s[20:23], s65 offen offset:0 lds
    buffer_load_dwordx4 v7, s[20:23], s65 offen offset:1024 lds
    buffer_load_dwordx4 v8, s[20:23], s65 offen offset:2048 lds
    buffer_load_dwordx4 v9, s[20:23], s65 offen offset:3072 lds
    s_bitcmp1_b32 s4, 1
    s_cbranch_scc1 L_norl
    buffer_load_dwordx4 v[128:131], v37, s[40:43], s53 offen offset:0 sc1
    buffer_load_dwordx4 v[132:135], v37, s[40:43], s53 offen offset:1024 sc1
    buffer_load_dwordx4 v[136:139], v37, s[40:43], s53 offen offset:2048 sc1
    buffer_load_dwordx4 v[140:143], v37, s[40:43], s53 offen offset:3072 sc1
    buffer_load_dwordx4 v[144:147], v38, s[40:43], s53 offen sc1
L_norl:
    s_add_u32 m0, s63, 0x18000
    s_add_u32 s65, s95, 0x40000
    buffer_load_dwordx4 v6, s[20:23], s65 offen offset:0 lds
    v_max3_f32 v20, v212, v213, v214
    v_min3_f32 v21, v212, v213, v214
    v_max3_f32 v20, v20, v215, v216
    v_min3_f32 v21, v21, v215, v216
    v_max3_f32 v20, v20, v217, v218
    v_min3_f32 v21, v21, v217, v218
    v_max3_f32 v20, v20, v219, v220
    v_min3_f32 v21, v21, v219, v220
    v_max3_f32 v20, v20, v221, v222
    v_min3_f32 v21, v21, v221, v222
    v_max3_f32 v20, v20, v223, v224
    v_min3_f32 v21, v21, v223, v224
    v_max3_f32 v20, v20, v225, v226
    v_min3_f32 v21, v21, v225, v226
    buffer_load_dwordx4 v7, s[20:23], s65 offen offset:1024 lds
    v_max_f32 v20, v20, v227
    v_min_f32 v21, v21, v227
    v_pk_mul_f32 v[20:21], v[20:21], v[92:93] op_sel:[0,1] op_sel_hi:[1,1]
    v_pk_fma_f32 v[228:229], v[212:213], v[92:93], v[20:21] op_sel:[0,1,1] op_sel_hi:[1,1,1] neg_lo:[0,1,0] neg_hi:[0,1,0]
    v_pk_fma_f32 v[212:213], v[212:213], v[92:93], v[20:21] op_sel:[0,1,0] op_sel_hi:[1,1,0] neg_lo:[0,0,1] neg_hi:[0,0,1]
    v_exp_f32 v228, v228
    v_pk_fma_f32 v[230:231], v[214:215], v[92:93], v[20:21] op_sel:[0,1,1] op_sel_hi:[1,1,1] neg_lo:[0,1,0] neg_hi:[0,1,0]
    v_exp_f32 v229, v229
    v_pk_fma_f32 v[214:215], v[214:215], v[92:93], v[20:21] op_sel:[0,1,0] op_sel_hi:[1,1,0] neg_lo:[0,0,1] neg_hi:[0,0,1]
    v_exp_f32 v212, v212
    v_exp_f32 v213, v213
    v_exp_f32 v230, v230
    v_pk_fma_f32 v[232:233], v[216:217], v[92:93], v[20:21] op_sel:[0,1,1] op_sel_hi:[1,1,1] neg_lo:[0,1,0] neg_hi:[0,1,0]
    v_exp_f32 v231, v231
    buffer_load_dwordx4 v8, s[20:23], s65 offen offset:2048 lds
    v_pk_fma_f32 v[216:217], v[216:217], v[92:93], v[20:21] op_sel:[0,1,0] op_sel_hi:[1,1,0] neg_lo:[0,0,1] neg_hi:[0,0,1]
    v_exp_f32 v214, v214
    v_exp_f32 v215, v215
    v_exp_f32 v232, v232
    v_pk_fma_f32 v[234:235], v[218:219], v[92:93], v[20:21] op_sel:[0,1,1] op_sel_hi:[1,1,1] neg_lo:[0,1,0] neg_hi:[0,1,0]
    v_exp_f32 v233, v233
    v_pk_fma_f32 v[218:219], v[218:219], v[92:93], v[20:21] op_sel:[0,1,0] op_sel_hi:[1,1,0] neg_lo:[0,0,1] neg_hi:[0,0,1]
    v_exp_f32 v216, v216
    v_pk_add_f32 v[24:25], v[228:229], v[230:231] op_sel:[0,0] op_sel_hi:[1,1]
    v_exp_f32 v217, v217
    v_pk_add_f32 v[22:23], v[212:213], v[214:215] op_sel:[0,0] op_sel_hi:[1,1]
    v_exp_f32 v234, v234
    v_pk_fma_f32 v[236:237], v[220:221], v[92:93], v[20:21] op_sel:[0,1,1] op_sel_hi:[1,1,1] neg_lo:[0,1,0] neg_hi:[0,1,0]
    v_exp_f32 v235, v235
    buffer_load_dwordx4 v9, s[20:23], s65 offen offset:3072 lds
    v_pk_fma_f32 v[220:221], v[220:221], v[92:93], v[20:21] op_sel:[0,1,0] op_sel_hi:[1,1,0] neg_lo:[0,0,1] neg_hi:[0,0,1]
    v_exp_f32 v218, v218
    v_pk_add_f32 v[24:25], v[24:25], v[232:233] op_sel:[0,0] op_sel_hi:[1,1]
    v_exp_f32 v219, v219
    v_pk_add_f32 v[22:23], v[22:23], v[216:217] op_sel:[0,0] op_sel_hi:[1,1]
    v_exp_f32 v236, v236
    v_pk_fma_f32 v[238:239], v[222:223], v[92:93], v[20:21] op_sel:[0,1,1] op_sel_hi:[1,1,1] neg_lo:[0,1,0] neg_hi:[0,1,0]
    v_exp_f32 v237, v237
    v_pk_fma_f32 v[222:223], v[222:223], v[92:93], v[20:21] op_sel:[0,1,0] op_sel_hi:[1,1,0] neg_lo:[0,0,1] neg_hi:[0,0,1]
    v_exp_f32 v220, v220
    v_pk_add_f32 v[24:25], v[24:25], v[234:235] op_sel:[0,0] op_sel_hi:[1,1]
    v_exp_f32 v221, v221
    v_pk_add_f32 v[22:23], v[22:23], v[218:219] op_sel:[0,0] op_sel_hi:[1,1]
    v_exp_f32 v238, v238
    s_lshl_b32 s50, s45, 12
    s_add_u32 s50, s50, 0x2c0000
    s_bitcmp1_b32 s4, 1
    s_cbranch_scc1 L_nored
    s_waitcnt vmcnt(8)
    v_xor_b32 v128, s61, v128
    v_xor_b32 v129, s89, v129
    v_xor_b32 v130, s90, v130
    v_xor_b32 v131, s91, v131
    s_waitcnt vmcnt(7)
    v_xor_b32 v132, s61, v132
    v_xor_b32 v133, s89, v133
    v_xor_b32 v134, s90, v134
    v_xor_b32 v135, s91, v135
    s_waitcnt vmcnt(6)
    v_xor_b32 v136, s61, v136
    v_xor_b32 v137, s89, v137
    v_xor_b32 v138, s90, v138
    v_xor_b32 v139, s91, v139
    s_waitcnt vmcnt(5)
    v_xor_b32 v140, s61, v140
    v_xor_b32 v141, s89, v141
    v_xor_b32 v142, s90, v142
    v_xor_b32 v143, s91, v143
    s_waitcnt vmcnt(4)
    v_xor_b32 v144, s61, v144
    v_xor_b32 v145, s89, v145
    v_xor_b32 v146, s90, v146
    v_xor_b32 v147, s91, v147
    v_or3_b32 v196, v128, v129, v130
    v_or3_b32 v196, v196, v131, v132
    v_or3_b32 v196, v196, v133, v134
    v_or3_b32 v196, v196, v135, v136
    v_or3_b32 v196, v196, v137, v138
    v_or3_b32 v196, v196, v139, v140
    v_or3_b32 v196, v196, v141, v142
    v_bitop3_b32 v196, v196, v143, v39 bitop3:0xa8
    v_or3_b32 v197, v144, v145, v146
    v_bitop3_b32 v197, v197, v147, v40 bitop3:0xa8
    v_or_b32 v196, v196, v197
    v_cmp_ne_u32 vcc, 0, v196
    s_cbranch_vccnz Lr_red
Lb_red:
    v_pk_add_f32 v[128:129], v[128:129], v[132:133] op_sel:[0,0] op_sel_hi:[1,1]
    v_pk_add_f32 v[130:131], v[130:131], v[134:135] op_sel:[0,0] op_sel_hi:[1,1]
    v_pk_add_f32 v[136:137], v[136:137], v[140:141] op_sel:[0,0] op_sel_hi:[1,1]
    v_pk_add_f32 v[138:139], v[138:139], v[142:143] op_sel:[0,0] op_sel_hi:[1,1]
    v_pk_add_f32 v[128:129], v[128:129], v[136:137] op_sel:[0,0] op_sel_hi:[1,1]
    v_pk_add_f32 v[130:131], v[130:131], v[138:139] op_sel:[0,0] op_sel_hi:[1,1]
    v_permlane32_swap_b32 v144, v146
    v_permlane32_swap_b32 v145, v147
    v_permlane32_swap_b32 v128, v130
    v_permlane32_swap_b32 v129, v131
    v_pk_add_f32 v[144:145], v[144:145], v[146:147] op_sel:[0,0] op_sel_hi:[1,1]
    v_pk_add_f32 v[128:129], v[128:129], v[130:131] op_sel:[0,0] op_sel_hi:[1,1]
    s_nop 0
    v_permlane16_swap_b32 v144, v145
    v_permlane16_swap_b32 v128, v129
    v_add_f32 v144, v144, v145
    v_add_f32 v128, v128, v129
    s_mov_b32 vcc_lo, 0xff00ff00
    s_mov_b32 vcc_hi, 0xff00ff00
    v_add_f32_dpp v144, v144, v144 row_ror:8 row_mask:0xf bank_mask:0xf
    v_add_f32_dpp v128, v128, v128 row_ror:8 row_mask:0xf bank_mask:0xf
    s_nop 0
    v_add_f32_dpp v144, v144, v144 quad_perm:[1,0,3,2] row_mask:0xf bank_mask:0xf
    s_nop 1
    v_add_f32_dpp v144, v144, v144 quad_perm:[2,3,0,1] row_mask:0xf bank_mask:0xf
    v_cndmask_b32 v129, v128, v144, vcc
    v_cndmask_b32 v128, v128, v144, vcc
    s_nop 1
    v_permlane16_swap_b32 v128, v129
    v_cvt_pk_bf16_f32 v132, v128, v129
    v_cvt_pk_bf16_f32 v133, v128, v129
    s_nop 1
    v_permlane32_swap_b32 v132, v133
    v_cndmask_b32 v130, v16, v132, s[100:101]
    v_cndmask_b32 v131, v16, v133, s[100:101]
    v_cndmask_b32 v128, v132, v16, s[100:101]
    v_cndmask_b32 v129, v133, v16, s[100:101]
L_nored:
    buffer_store_dwordx4 v[128:131], v36, s[40:43], s50 offen sc1
    v_lshlrev_b32 v80, 7, v15
    s_add_u32 m0, s63, 0x1c000
    s_add_u32 s65, s95, 0x60000
    buffer_load_dwordx4 v6, s[20:23], s65 offen offset:0 lds
    v_pk_fma_f32 v[240:241], v[224:225], v[92:93], v[20:21] op_sel:[0,1,1] op_sel_hi:[1,1,1] neg_lo:[0,1,0] neg_hi:[0,1,0]
    v_exp_f32 v239, v239
    v_pk_fma_f32 v[224:225], v[224:225], v[92:93], v[20:21] op_sel:[0,1,0] op_sel_hi:[1,1,0] neg_lo:[0,0,1] neg_hi:[0,0,1]
    v_exp_f32 v222, v222
    buffer_load_dwordx4 v7, s[20:23], s65 offen offset:1024 lds
    v_pk_add_f32 v[24:25], v[24:25], v[236:237] op_sel:[0,0] op_sel_hi:[1,1]
    v_exp_f32 v223, v223
    v_pk_add_f32 v[22:23], v[22:23], v[220:221] op_sel:[0,0] op_sel_hi:[1,1]
    v_exp_f32 v240, v240
    buffer_load_dwordx4 v8, s[20:23], s65 offen offset:2048 lds
    v_pk_fma_f32 v[242:243], v[226:227], v[92:93], v[20:21] op_sel:[0,1,1] op_sel_hi:[1,1,1] neg_lo:[0,1,0] neg_hi:[0,1,0]
    v_exp_f32 v241, v241
    v_pk_fma_f32 v[226:227], v[226:227], v[92:93], v[20:21] op_sel:[0,1,0] op_sel_hi:[1,1,0] neg_lo:[0,0,1] neg_hi:[0,0,1]
    v_exp_f32 v224, v224
    buffer_load_dwordx4 v9, s[20:23], s65 offen offset:3072 lds
    v_pk_add_f32 v[24:25], v[24:25], v[238:239] op_sel:[0,0] op_sel_hi:[1,1]
    v_exp_f32 v225, v225
    v_pk_add_f32 v[22:23], v[22:23], v[222:223] op_sel:[0,0] op_sel_hi:[1,1]
    v_exp_f32 v242, v242
    s_and_b32 s69, s2, 0x7f
    s_lshl_b32 s69, s69, 2
    s_add_u32 s69, s69, s3
    s_mul_i32 s68, s69, 0xb00
    s_bitcmp1_b32 s4, 1
    s_cselect_b32 s68, s68, 0x40000000
    v_lshl_add_u32 v68, v0, 7, s68
    s_mov_b64 exec, 0x3fffff
    buffer_load_dword v69, v68, s[28:31], 0 offen
    s_mov_b64 exec, -1
    v_pk_add_f32 v[24:25], v[24:25], v[240:241] op_sel:[0,0] op_sel_hi:[1,1]
    v_exp_f32 v243, v243
    v_pk_add_f32 v[22:23], v[22:23], v[224:225] op_sel:[0,0] op_sel_hi:[1,1]
    v_exp_f32 v226, v226
    s_add_u32 m0, s66, 0
    s_add_u32 s65, s0, 0
    s_and_b32 s65, s65, 3
    s_mul_i32 s65, s65, 0x56000
    s_add_u32 s57, s65, s67
    s_add_u32 s65, s57, 0
    buffer_load_dwordx4 v32, s[24:27], s65 offen offset:0 lds
    v_exp_f32 v227, v227
    v_pk_add_f32 v[24:25], v[24:25], v[242:243] op_sel:[0,0] op_sel_hi:[1,1]
    v_pk_add_f32 v[22:23], v[22:23], v[226:227] op_sel:[0,0] op_sel_hi:[1,1]
    v_add_f32 v24, v24, v25
    buffer_load_dwordx4 v33, s[24:27], s65 offen offset:1024 lds
    v_add_f32 v22, v22, v23
    v_rcp_f32 v24, v24
    v_rcp_f32 v22, v22
    v_pk_mul_f32 v[228:229], v[228:229], v[24:25] op_sel:[0,0] op_sel_hi:[1,0]
    buffer_load_dwordx4 v34, s[24:27], s65 offen offset:2048 lds
    v_pk_mul_f32 v[212:213], v[212:213], v[22:23] op_sel:[0,0] op_sel_hi:[1,0]
    v_pk_mul_f32 v[230:231], v[230:231], v[24:25] op_sel:[0,0] op_sel_hi:[1,0]
    v_pk_mul_f32 v[214:215], v[214:215], v[22:23] op_sel:[0,0] op_sel_hi:[1,0]
    v_cvt_pk_bf16_f32 v212, v212, v213
    s_add_u32 m0, s66, 0xc00
    s_add_u32 s65, s57, 0xac00
    buffer_load_dwordx4 v32, s[24:27], s65 offen offset:0 lds
    v_cvt_pk_bf16_f32 v213, v214, v215
    v_cvt_pk_bf16_f32 v214, v228, v229
    v_cvt_pk_bf16_f32 v215, v230, v231
    ds_write_b128 v82, v[212:215] offset:0
    buffer_load_dwordx4 v33, s[24:27], s65 offen offset:1024 lds
    v_pk_mul_f32 v[232:233], v[232:233], v[24:25] op_sel:[0,0] op_sel_hi:[1,0]
    v_pk_mul_f32 v[216:217], v[216:217], v[22:23] op_sel:[0,0] op_sel_hi:[1,0]
    v_pk_mul_f32 v[234:235], v[234:235], v[24:25] op_sel:[0,0] op_sel_hi:[1,0]
    v_pk_mul_f32 v[218:219], v[218:219], v[22:23] op_sel:[0,0] op_sel_hi:[1,0]
    buffer_load_dwordx4 v34, s[24:27], s65 offen offset:2048 lds
    v_cvt_pk_bf16_f32 v216, v216, v217
    v_cvt_pk_bf16_f32 v217, v218, v219
    v_cvt_pk_bf16_f32 v218, v232, v233
    v_cvt_pk_bf16_f32 v219, v234, v235
    s_add_u32 m0, s66, 0x1800
    s_add_u32 s65, s57, 0x15800
    buffer_load_dwordx4 v32, s[24:27], s65 offen offset:0 lds
    ds_write_b128 v82, v[216:219] offset:16
    v_pk_mul_f32 v[236:237], v[236:237], v[24:25] op_sel:[0,0] op_sel_hi:[1,0]
    v_pk_mul_f32 v[220:221], v[220:221], v[22:23] op_sel:[0,0] op_sel_hi:[1,0]
    v_pk_mul_f32 v[238:239], v[238:239], v[24:25] op_sel:[0,0] op_sel_hi:[1,0]
    buffer_load_dwordx4 v33, s[24:27], s65 offen offset:1024 lds
    v_pk_mul_f32 v[222:223], v[222:223], v[22:23] op_sel:[0,0] op_sel_hi:[1,0]
    v_cvt_pk_bf16_f32 v220, v220, v221
    v_cvt_pk_bf16_f32 v221, v222, v223
    v_cvt_pk_bf16_f32 v222, v236, v237
    buffer_load_dwordx4 v34, s[24:27], s65 offen offset:2048 lds
    v_cvt_pk_bf16_f32 v223, v238, v239
    ds_write_b128 v82, v[220:223] offset:32
    v_pk_mul_f32 v[240:241], v[240:241], v[24:25] op_sel:[0,0] op_sel_hi:[1,0]
    v_pk_mul_f32 v[224:225], v[224:225], v[22:23] op_sel:[0,0] op_sel_hi:[1,0]
    s_add_u32 m0, s66, 0x2400
    s_add_u32 s65, s57, 0x20400
    buffer_load_dwordx4 v32, s[24:27], s65 offen offset:0 lds
    v_pk_mul_f32 v[242:243], v[242:243], v[24:25] op_sel:[0,0] op_sel_hi:[1,0]
    v_pk_mul_f32 v[226:227], v[226:227], v[22:23] op_sel:[0,0] op_sel_hi:[1,0]
    v_cvt_pk_bf16_f32 v224, v224, v225
    v_cvt_pk_bf16_f32 v225, v226, v227
    buffer_load_dwordx4 v33, s[24:27], s65 offen offset:1024 lds
    v_cvt_pk_bf16_f32 v226, v240, v241
    v_cvt_pk_bf16_f32 v227, v242, v243
    ds_write_b128 v82, v[224:227] offset:48
    ds_read_b128 v[160:163], v84 offset:0
    buffer_load_dwordx4 v34, s[24:27], s65 offen offset:2048 lds
    ds_read_b128 v[164:167], v84 offset:1280
    ds_read_b128 v[168:171], v84 offset:2560
    ds_read_b128 v[172:175], v84 offset:3840
    s_waitcnt vmcnt(13)
    s_barrier
    ds_read_b64_tr_b16 a[192:193], v10 offset:0
    ds_read_b64_tr_b16 a[194:195], v10 offset:512
    ds_read_b64_tr_b16 a[196:197], v10 offset:4096
    ds_read_b64_tr_b16 a[198:199], v10 offset:4608
    ds_read_b64_tr_b16 a[200:201], v10 offset:8192
    ds_read_b64_tr_b16 a[202:203], v10 offset:8704
    ds_read_b64_tr_b16 a[204:205], v10 offset:12288
    ds_read_b64_tr_b16 a[206:207], v10 offset:12800
    v_xor_b32 v73, 0x4000, v10
    ds_read_b64_tr_b16 a[208:209], v73 offset:0
    ds_read_b64_tr_b16 a[210:211], v73 offset:512
    ds_read_b64_tr_b16 a[212:213], v73 offset:4096
    ds_read_b64_tr_b16 a[214:215], v73 offset:4608
    ds_read_b64_tr_b16 a[216:217], v73 offset:8192
    ds_read_b64_tr_b16 a[218:219], v73 offset:8704
    ds_read_b64_tr_b16 a[220:221], v73 offset:12288
    ds_read_b64_tr_b16 a[222:223], v73 offset:12800
    v_xor_b32 v74, 0x8000, v10
    ds_read_b64_tr_b16 a[224:225], v74 offset:0
    ds_read_b64_tr_b16 a[226:227], v74 offset:512
    ds_read_b64_tr_b16 a[228:229], v74 offset:4096
    ds_read_b64_tr_b16 a[230:231], v74 offset:4608
    ds_read_b64_tr_b16 a[232:233], v74 offset:8192
    ds_read_b64_tr_b16 a[234:235], v74 offset:8704
    ds_read_b64_tr_b16 a[236:237], v74 offset:12288
    ds_read_b64_tr_b16 a[238:239], v74 offset:12800
    v_xor_b32 v75, 0xc000, v10
    ds_read_b64_tr_b16 a[240:241], v75 offset:0
    ds_read_b64_tr_b16 a[242:243], v75 offset:512
    ds_read_b64_tr_b16 a[244:245], v75 offset:4096
    ds_read_b64_tr_b16 a[246:247], v75 offset:4608
    ds_read_b64_tr_b16 a[248:249], v75 offset:8192
    ds_read_b64_tr_b16 a[250:251], v75 offset:8704
    ds_read_b64_tr_b16 a[252:253], v75 offset:12288
    ds_read_b64_tr_b16 a[254:255], v75 offset:12800
    buffer_load_dwordx4 v[152:155], v80, s[40:43], s50 offen offset:2048 sc1
    buffer_load_dwordx4 v[156:159], v80, s[40:43], s50 offen offset:2560 sc1
    buffer_load_dwordx4 v[144:147], v1, s[40:43], s50 offen sc1
    buffer_load_dwordx4 v[148:151], v1, s[40:43], s50 offen offset:1024 sc1
    s_waitcnt lgkmcnt(0)
    s_barrier
    s_add_u32 m0, s66, 0x10000
    s_add_u32 s65, s0, 1
    s_and_b32 s65, s65, 3
    s_mul_i32 s65, s65, 0x56000
    s_add_u32 s57, s65, s67
    s_add_u32 s65, s57, 0
    buffer_load_dwordx4 v32, s[24:27], s65 offen offset:0 lds
    buffer_load_dwordx4 v33, s[24:27], s65 offen offset:1024 lds
    buffer_load_dwordx4 v34, s[24:27], s65 offen offset:2048 lds
    s_add_u32 m0, s66, 0x10c00
    s_add_u32 s65, s57, 0xac00
    buffer_load_dwordx4 v32, s[24:27], s65 offen offset:0 lds
    buffer_load_dwordx4 v33, s[24:27], s65 offen offset:1024 lds
    buffer_load_dwordx4 v34, s[24:27], s65 offen offset:2048 lds
    s_lshr_b32 s68, s4, 2
    s_lshl_b32 s68, s68, 8
    s_and_b32 s69, s4, 1
    s_lshl_b32 s69, s69, 7
    s_add_u32 s68, s68, s69
    s_lshr_b32 s69, s4, 4
    s_lshl_b32 s69, s69, 3
    s_add_u32 s68, s68, s69
    s_lshl_b32 s69, s3, 15
    s_add_u32 s68, s68, s69
    s_add_u32 s68, s68, 0x2c0000
    v_and_b32 v208, 7, v0
    v_lshl_add_u32 v208, v208, 12, s68
    s_waitcnt vmcnt(9)
    v_xor_b32 v81, s88, v152
    s_waitcnt vmcnt(8)
    v_bitop3_b32 v81, v81, v158, s88 bitop3:0xf6
    s_waitcnt vmcnt(7)
    v_bitop3_b32 v81, v81, v144, s88 bitop3:0xf6
    s_waitcnt vmcnt(6)
    v_bitop3_b32 v81, v81, v150, s88 bitop3:0xf6
    v_cmp_ne_u32 vcc, 0, v81
    s_cbranch_vccnz Lr_kvf
Lb_kvf:
    v_mfma_f32_16x16x32_bf16 v[228:231], v[154:157], v[160:163], 0
    v_mfma_f32_16x16x32_bf16 v[232:235], v[154:157], v[164:167], 0
    v_mfma_f32_16x16x32_bf16 v[236:239], v[154:157], v[168:171], 0
    v_mfma_f32_16x16x32_bf16 v[240:243], v[154:157], v[172:175], 0
    v_mfma_f32_16x16x32_bf16 v[212:215], v[146:149], v[160:163], 0
    s_nop 3
    v_add_f32 v228, 0x358637bd, v228
    v_rcp_f32 v228, v228
    v_mfma_f32_16x16x32_bf16 v[216:219], v[146:149], v[164:167], 0
    v_add_f32 v232, 0x358637bd, v232
    v_rcp_f32 v232, v232
    v_mfma_f32_16x16x32_bf16 v[220:223], v[146:149], v[168:171], 0
    v_add_f32 v236, 0x358637bd, v236
    v_rcp_f32 v236, v236
    v_mfma_f32_16x16x32_bf16 v[224:227], v[146:149], v[172:175], 0
    v_add_f32 v240, 0x358637bd, v240
    v_rcp_f32 v240, v240
    v_pk_mul_f32 v[212:213], v[212:213], v[228:229] op_sel:[0,0] op_sel_hi:[1,0]
    v_pk_mul_f32 v[214:215], v[214:215], v[228:229] op_sel:[0,0] op_sel_hi:[1,0]
    v_cvt_pk_bf16_f32 v248, v212, v213
    v_cvt_pk_bf16_f32 v249, v214, v215
    v_pk_mul_f32 v[216:217], v[216:217], v[232:233] op_sel:[0,0] op_sel_hi:[1,0]
    v_pk_mul_f32 v[218:219], v[218:219], v[232:233] op_sel:[0,0] op_sel_hi:[1,0]
    v_cvt_pk_bf16_f32 v250, v216, v217
    v_cvt_pk_bf16_f32 v251, v218, v219
    s_nop 0
    v_permlane16_swap_b32 v248, v250
    v_permlane16_swap_b32 v249, v251
    v_or_b32 v248, 1, v248
    buffer_store_dwordx4 v[248:251], v42, s[40:43], s86 offen
    v_pk_mul_f32 v[220:221], v[220:221], v[236:237] op_sel:[0,0] op_sel_hi:[1,0]
    v_pk_mul_f32 v[222:223], v[222:223], v[236:237] op_sel:[0,0] op_sel_hi:[1,0]
    v_cvt_pk_bf16_f32 v252, v220, v221
    v_cvt_pk_bf16_f32 v253, v222, v223
    v_pk_mul_f32 v[224:225], v[224:225], v[240:241] op_sel:[0,0] op_sel_hi:[1,0]
    v_pk_mul_f32 v[226:227], v[226:227], v[240:241] op_sel:[0,0] op_sel_hi:[1,0]
    v_cvt_pk_bf16_f32 v254, v224, v225
    v_cvt_pk_bf16_f32 v255, v226, v227
    s_nop 0
    v_permlane16_swap_b32 v252, v254
    v_permlane16_swap_b32 v253, v255
    v_or_b32 v252, 1, v252
    buffer_store_dwordx4 v[252:255], v42, s[40:43], s87 offen
    buffer_load_dword v209, v208, s[40:43], 0 offen sc1
    s_add_u32 m0, s66, 0x11800
    s_add_u32 s65, s57, 0x15800
    buffer_load_dwordx4 v32, s[24:27], s65 offen offset:0 lds
    buffer_load_dwordx4 v33, s[24:27], s65 offen offset:1024 lds
    buffer_load_dwordx4 v34, s[24:27], s65 offen offset:2048 lds
    s_add_u32 m0, s66, 0x12400
    s_add_u32 s65, s57, 0x20400
    buffer_load_dwordx4 v32, s[24:27], s65 offen offset:0 lds
    buffer_load_dwordx4 v33, s[24:27], s65 offen offset:1024 lds
    buffer_load_dwordx4 v34, s[24:27], s65 offen offset:2048 lds
    s_barrier
    ds_read_b64_tr_b16 a[0:1], v44 offset:0
    ds_read_b64_tr_b16 a[2:3], v44 offset:768
    ds_read_b64_tr_b16 a[4:5], v45 offset:0
    ds_read_b64_tr_b16 a[6:7], v45 offset:768
    ds_read_b64_tr_b16 a[8:9], v46 offset:0
    ds_read_b64_tr_b16 a[10:11], v46 offset:768
    ds_read_b64_tr_b16 a[12:13], v44 offset:6144
    ds_read_b64_tr_b16 a[14:15], v44 offset:6912
    ds_read_b64_tr_b16 a[16:17], v45 offset:6144
    ds_read_b64_tr_b16 a[18:19], v45 offset:6912
    ds_read_b64_tr_b16 a[20:21], v46 offset:6144
    ds_read_b64_tr_b16 a[22:23], v46 offset:6912
    ds_read_b64_tr_b16 a[24:25], v44 offset:24576
    ds_read_b64_tr_b16 a[26:27], v44 offset:25344
    ds_read_b64_tr_b16 a[28:29], v45 offset:24576
    ds_read_b64_tr_b16 a[30:31], v45 offset:25344
    ds_read_b64_tr_b16 a[32:33], v46 offset:24576
    ds_read_b64_tr_b16 a[34:35], v46 offset:25344
    ds_read_b64_tr_b16 a[36:37], v44 offset:30720
    ds_read_b64_tr_b16 a[38:39], v44 offset:31488
    ds_read_b64_tr_b16 a[40:41], v45 offset:30720
    ds_read_b64_tr_b16 a[42:43], v45 offset:31488
    ds_read_b64_tr_b16 a[44:45], v46 offset:30720
    ds_read_b64_tr_b16 a[46:47], v46 offset:31488
    s_waitcnt lgkmcnt(0)
    s_barrier
    s_add_u32 m0, s66, 0
    s_add_u32 s65, s0, 2
    s_and_b32 s65, s65, 3
    s_mul_i32 s65, s65, 0x56000
    s_add_u32 s57, s65, s67
    s_add_u32 s65, s57, 0
    buffer_load_dwordx4 v32, s[24:27], s65 offen offset:0 lds
    v_mfma_f32_16x16x32_bf16 v[56:59], a[0:3], v[28:31], 0
    v_mfma_f32_16x16x32_bf16 v[60:63], a[4:7], v[28:31], 0
    v_mfma_f32_16x16x32_bf16 v[64:67], a[8:11], v[28:31], 0
    v_mfma_f32_16x16x32_bf16 v[56:59], a[12:15], v[28:31], v[56:59]
    v_mfma_f32_16x16x32_bf16 v[60:63], a[16:19], v[28:31], v[60:63]
    v_mfma_f32_16x16x32_bf16 v[64:67], a[20:23], v[28:31], v[64:67]
    v_mfma_f32_16x16x32_bf16 v[56:59], a[24:27], v[28:31], v[56:59]
    v_mfma_f32_16x16x32_bf16 v[60:63], a[28:31], v[28:31], v[60:63]
    v_mfma_f32_16x16x32_bf16 v[64:67], a[32:35], v[28:31], v[64:67]
    v_mfma_f32_16x16x32_bf16 v[56:59], a[36:39], v[28:31], v[56:59]
    buffer_load_dwordx4 v33, s[24:27], s65 offen offset:1024 lds
    v_mfma_f32_16x16x32_bf16 v[60:63], a[40:43], v[28:31], v[60:63]
    v_mfma_f32_16x16x32_bf16 v[64:67], a[44:47], v[28:31], v[64:67]
    v_lshlrev_b32 v176, 16, v48
    v_and_b32 v177, 0xffff0000, v48
    v_lshlrev_b32 v178, 16, v49
    v_and_b32 v179, 0xffff0000, v49
    v_lshlrev_b32 v180, 16, v50
    v_and_b32 v181, 0xffff0000, v50
    v_lshlrev_b32 v182, 16, v51
    buffer_load_dwordx4 v34, s[24:27], s65 offen offset:2048 lds
    v_and_b32 v183, 0xffff0000, v51
    v_lshlrev_b32 v184, 16, v52
    v_and_b32 v185, 0xffff0000, v52
    v_lshlrev_b32 v186, 16, v53
    v_and_b32 v187, 0xffff0000, v53
    v_lshlrev_b32 v188, 16, v54
    v_and_b32 v189, 0xffff0000, v54
    v_lshlrev_b32 v190, 16, v55
    v_and_b32 v191, 0xffff0000, v55
    s_add_u32 m0, s66, 0xc00
    s_add_u32 s65, s57, 0xac00
    buffer_load_dwordx4 v32, s[24:27], s65 offen offset:0 lds
    v_add_u32 v40, 0x1c000, v1
    v_add_u32 v200, s63, v27
    v_xor_b32 v202, 0x1000, v200
    v_xor_b32 v204, 0x2000, v200
    v_xor_b32 v206, 0x3000, v200
    v_add_u32 v201, s63, v40
    v_xor_b32 v203, 0x1000, v201
    v_xor_b32 v205, 0x2000, v201
    v_xor_b32 v207, 0x3000, v201
    buffer_load_dwordx4 v33, s[24:27], s65 offen offset:1024 lds
    v_bfe_i32 v140, v0, 5, 1
    s_bitcmp1_b32 s3, 0
    s_cselect_b32 s51, 0, s1
    s_cselect_b32 s52, s1, 0
    v_and_b32 v137, s51, v140
    v_and_b32 v139, s52, v140
    v_xor_b32 v136, s51, v137
    v_xor_b32 v138, s52, v139
    s_lshl_b32 s68, s3, 14
    s_sub_u32 s68, s63, s68
    s_sub_u32 s68, s68, 0x10000
    v_add_u32 v10, s68, v10
    v_add_u32 v11, s68, v11
    v_add_u32 v12, s68, v12
    v_add_u32 v13, s68, v13
    buffer_load_dwordx4 v34, s[24:27], s65 offen offset:2048 lds
    v_lshl_add_u32 v19, v15, 2, v200
    v_lshl_add_u32 v42, v15, 2, v201
    v_xor_b32 v24, s96, v41
    s_waitcnt vmcnt(12)
    v_cmp_ne_u32 vcc, s88, v209
    s_cbranch_vccnz Lr_kx
Lb_kx:
    s_add_u32 m0, s63, 0xc000
    s_nop 0
    buffer_load_dwordx4 v2, s[40:43], s81 offen offset:0 sc1 lds
    buffer_load_dwordx4 v2, s[40:43], s82 offen offset:1024 sc1 lds
    buffer_load_dwordx4 v2, s[40:43], s83 offen offset:2048 sc1 lds
    buffer_load_dwordx4 v2, s[40:43], s84 offen offset:3072 sc1 lds
    s_add_u32 m0, s63, 0x1c000
    s_nop 0
    buffer_load_dwordx4 v3, s[40:43], s81 offen offset:0 sc1 lds
    buffer_load_dwordx4 v3, s[40:43], s82 offen offset:1024 sc1 lds
    buffer_load_dwordx4 v3, s[40:43], s83 offen offset:2048 sc1 lds
    buffer_load_dwordx4 v3, s[40:43], s84 offen offset:3072 sc1 lds
    s_waitcnt vmcnt(14)
    s_barrier
    s_add_u32 m0, s63, 0x20000
    s_nop 0
    buffer_load_dwordx4 v4, s[40:43], s81 offen offset:0 sc1 lds
    v_add_u32 v44, 0x10000, v44
    v_add_u32 v45, 0x10000, v45
    v_add_u32 v46, 0x10000, v46
    ds_read_b64_tr_b16 a[48:49], v44 offset:0
    ds_read_b64_tr_b16 a[50:51], v44 offset:768
    buffer_load_dwordx4 v4, s[40:43], s82 offen offset:1024 sc1 lds
    ds_read_b64_tr_b16 a[52:53], v45 offset:0
    ds_read_b64_tr_b16 a[54:55], v45 offset:768
    ds_read_b64_tr_b16 a[56:57], v46 offset:0
    ds_read_b64_tr_b16 a[58:59], v46 offset:768
    ds_read_b64_tr_b16 a[60:61], v44 offset:6144
    buffer_load_dwordx4 v4, s[40:43], s83 offen offset:2048 sc1 lds
    ds_read_b64_tr_b16 a[62:63], v44 offset:6912
    ds_read_b64_tr_b16 a[64:65], v45 offset:6144
    ds_read_b64_tr_b16 a[66:67], v45 offset:6912
    ds_read_b64_tr_b16 a[68:69], v46 offset:6144
    ds_read_b64_tr_b16 a[70:71], v46 offset:6912
    buffer_load_dwordx4 v4, s[40:43], s84 offen offset:3072 sc1 lds
    ds_read_b64_tr_b16 a[72:73], v44 offset:24576
    ds_read_b64_tr_b16 a[74:75], v44 offset:25344
    ds_read_b64_tr_b16 a[76:77], v45 offset:24576
    ds_read_b64_tr_b16 a[78:79], v45 offset:25344
    ds_read_b64_tr_b16 a[80:81], v46 offset:24576
    s_add_u32 m0, s63, 0x24000
    s_nop 0
    buffer_load_dwordx4 v5, s[40:43], s81 offen offset:0 sc1 lds
    ds_read_b64_tr_b16 a[82:83], v46 offset:25344
    ds_read_b64_tr_b16 a[84:85], v44 offset:30720
    ds_read_b64_tr_b16 a[86:87], v44 offset:31488
    ds_read_b64_tr_b16 a[88:89], v45 offset:30720
    ds_read_b64_tr_b16 a[90:91], v45 offset:31488
    buffer_load_dwordx4 v5, s[40:43], s82 offen offset:1024 sc1 lds
    ds_read_b64_tr_b16 a[92:93], v46 offset:30720
    ds_read_b64_tr_b16 a[94:95], v46 offset:31488
    s_waitcnt lgkmcnt(15)
    v_mfma_f32_16x16x32_bf16 v[56:59], a[48:51], v[28:31], v[56:59]
    v_mfma_f32_16x16x32_bf16 v[60:63], a[52:55], v[28:31], v[60:63]
    v_mfma_f32_16x16x32_bf16 v[64:67], a[56:59], v[28:31], v[64:67]
    buffer_load_dwordx4 v5, s[40:43], s83 offen offset:2048 sc1 lds
    v_mfma_f32_16x16x32_bf16 v[56:59], a[60:63], v[28:31], v[56:59]
    s_waitcnt lgkmcnt(14)
    v_mfma_f32_16x16x32_bf16 v[60:63], a[64:67], v[28:31], v[60:63]
    s_waitcnt lgkmcnt(12)
    v_mfma_f32_16x16x32_bf16 v[64:67], a[68:71], v[28:31], v[64:67]
    s_waitcnt lgkmcnt(10)
    v_mfma_f32_16x16x32_bf16 v[56:59], a[72:75], v[28:31], v[56:59]
    s_waitcnt lgkmcnt(8)
    v_mfma_f32_16x16x32_bf16 v[60:63], a[76:79], v[28:31], v[60:63]
    buffer_load_dwordx4 v5, s[40:43], s84 offen offset:3072 sc1 lds
    s_waitcnt lgkmcnt(6)
    v_mfma_f32_16x16x32_bf16 v[64:67], a[80:83], v[28:31], v[64:67]
    s_waitcnt lgkmcnt(4)
    v_mfma_f32_16x16x32_bf16 v[56:59], a[84:87], v[28:31], v[56:59]
    s_waitcnt lgkmcnt(2)
    v_mfma_f32_16x16x32_bf16 v[60:63], a[88:91], v[28:31], v[60:63]
    s_waitcnt lgkmcnt(0)
    v_mfma_f32_16x16x32_bf16 v[64:67], a[92:95], v[28:31], v[64:67]
    s_barrier
    s_waitcnt vmcnt(12)
    ds_read_b128 v[72:75], v200 offset:0
    ds_read_b128 v[76:79], v200 offset:1024
    ds_read_b128 v[80:83], v200 offset:2048
    ds_read_b128 v[84:87], v200 offset:3072
    s_waitcnt lgkmcnt(2)
    v_bitop3_b32 v25, v72, v76, 1 bitop3:0x80
    s_waitcnt lgkmcnt(0)
    v_bitop3_b32 v25, v25, v80, v84 bitop3:0x80
    v_cmp_eq_u32 vcc, 0, v25
    s_cbranch_vccnz Lr_o0
Lb_o0:
    s_waitcnt vmcnt(8)
    ds_read_b128 v[88:91], v201 offset:0
    ds_read_b128 v[92:95], v201 offset:1024
    ds_read_b128 v[96:99], v201 offset:2048
    ds_read_b128 v[100:103], v201 offset:3072
    s_waitcnt lgkmcnt(2)
    v_bitop3_b32 v25, v88, v92, 1 bitop3:0x80
    s_waitcnt lgkmcnt(0)
    v_bitop3_b32 v25, v25, v96, v100 bitop3:0x80
    v_cmp_eq_u32 vcc, 0, v25
    s_cbranch_vccnz Lr_o1
Lb_o1:
    s_barrier
    ds_read_b128 v[144:147], v202 offset:0
    ds_read_b128 v[148:151], v203 offset:0
    ds_read_b128 v[152:155], v202 offset:1024
    ds_read_b128 v[156:159], v203 offset:1024
    v_mfma_f32_16x16x32_bf16 v[176:179], a[192:195], v[72:75], v[176:179]
    ds_read_b128 v[160:163], v202 offset:2048
    s_add_u32 m0, s66, 0x1800
    s_add_u32 s65, s57, 0x15800
    v_mfma_f32_16x16x32_bf16 v[180:183], a[192:195], v[88:91], v[180:183]
    ds_read_b128 v[164:167], v203 offset:2048
    buffer_load_dwordx4 v32, s[24:27], s65 offen offset:0 lds
    v_mfma_f32_16x16x32_bf16 v[176:179], a[196:199], v[76:79], v[176:179]
    ds_read_b128 v[168:171], v202 offset:3072
    buffer_load_dwordx4 v33, s[24:27], s65 offen offset:1024 lds
    v_mfma_f32_16x16x32_bf16 v[180:183], a[196:199], v[92:95], v[180:183]
    ds_read_b128 v[172:175], v203 offset:3072
    s_waitcnt vmcnt(6)
    ds_read_b128 v[104:107], v201 offset:16384
    v_mfma_f32_16x16x32_bf16 v[176:179], a[200:203], v[80:83], v[176:179]
    ds_read_b128 v[108:111], v201 offset:17408
    ds_read_b128 v[112:115], v201 offset:18432
    v_mfma_f32_16x16x32_bf16 v[180:183], a[200:203], v[96:99], v[180:183]
    ds_read_b128 v[116:119], v201 offset:19456
    buffer_load_dwordx4 v34, s[24:27], s65 offen offset:2048 lds
    v_mfma_f32_16x16x32_bf16 v[176:179], a[204:207], v[84:87], v[176:179]
    s_add_u32 m0, s66, 0x2400
    s_add_u32 s65, s57, 0x20400
    buffer_load_dwordx4 v32, s[24:27], s65 offen offset:0 lds
    v_mfma_f32_16x16x32_bf16 v[180:183], a[204:207], v[100:103], v[180:183]
    s_waitcnt lgkmcnt(11)
    buffer_load_dwordx4 v33, s[24:27], s65 offen offset:1024 lds
    v_mfma_f32_16x16x32_bf16 v[176:179], a[208:211], v[144:147], v[176:179]
    s_waitcnt lgkmcnt(10)
    ds_read_b128 v[144:147], v204 offset:0
    buffer_load_dwordx4 v34, s[24:27], s65 offen offset:2048 lds
    v_mfma_f32_16x16x32_bf16 v[180:183], a[208:211], v[148:151], v[180:183]
    s_waitcnt lgkmcnt(10)
    ds_read_b128 v[148:151], v205 offset:0
    s_add_u32 m0, s66, 0x10000
    s_add_u32 s65, s0, 3
    s_and_b32 s65, s65, 3
    v_mfma_f32_16x16x32_bf16 v[176:179], a[212:215], v[152:155], v[176:179]
    s_waitcnt lgkmcnt(10)
    ds_read_b128 v[152:155], v204 offset:1024
    s_mul_i32 s65, s65, 0x56000
    s_add_u32 s57, s65, s67
    s_add_u32 s65, s57, 0
    v_mfma_f32_16x16x32_bf16 v[180:183], a[212:215], v[156:159], v[180:183]
    s_waitcnt lgkmcnt(10)
    ds_read_b128 v[156:159], v205 offset:1024
    s_waitcnt lgkmcnt(6)
    v_bitop3_b32 v25, v104, v108, 1 bitop3:0x80
    s_waitcnt lgkmcnt(4)
    v_bitop3_b32 v25, v25, v112, v116 bitop3:0x80
    v_cmp_eq_u32 vcc, 0, v25
    v_mfma_f32_16x16x32_bf16 v[176:179], a[216:219], v[160:163], v[176:179]
    ds_read_b128 v[160:163], v204 offset:2048
    buffer_load_dwordx4 v32, s[24:27], s65 offen offset:0 lds
    v_mfma_f32_16x16x32_bf16 v[180:183], a[216:219], v[164:167], v[180:183]
    ds_read_b128 v[164:167], v205 offset:2048
    s_cbranch_vccnz Lr_o2
Lb_o2:
    v_mfma_f32_16x16x32_bf16 v[176:179], a[220:223], v[168:171], v[176:179]
    ds_read_b128 v[168:171], v204 offset:3072
    buffer_load_dwordx4 v33, s[24:27], s65 offen offset:1024 lds
    v_mfma_f32_16x16x32_bf16 v[180:183], a[220:223], v[172:175], v[180:183]
    s_waitcnt lgkmcnt(6)
    ds_read_b128 v[172:175], v205 offset:3072
    buffer_load_dwordx4 v34, s[24:27], s65 offen offset:2048 lds
    v_mfma_f32_16x16x32_bf16 v[176:179], a[224:227], v[144:147], v[176:179]
    s_waitcnt lgkmcnt(6)
    ds_read_b128 v[144:147], v206 offset:0
    v_mfma_f32_16x16x32_bf16 v[180:183], a[224:227], v[148:151], v[180:183]
    s_waitcnt lgkmcnt(6)
    ds_read_b128 v[148:151], v207 offset:0
    s_waitcnt vmcnt(9)
    ds_read_b128 v[120:123], v201 offset:32768
    v_mfma_f32_16x16x32_bf16 v[176:179], a[228:231], v[152:155], v[176:179]
    s_waitcnt lgkmcnt(7)
    ds_read_b128 v[152:155], v206 offset:1024
    ds_read_b128 v[124:127], v201 offset:33792
    v_mfma_f32_16x16x32_bf16 v[180:183], a[228:231], v[156:159], v[180:183]
    s_waitcnt lgkmcnt(8)
    ds_read_b128 v[156:159], v207 offset:1024
    ds_read_b128 v[128:131], v201 offset:34816
    v_mfma_f32_16x16x32_bf16 v[176:179], a[232:235], v[160:163], v[176:179]
    s_waitcnt lgkmcnt(9)
    ds_read_b128 v[160:163], v206 offset:2048
    ds_read_b128 v[132:135], v201 offset:35840
    v_mfma_f32_16x16x32_bf16 v[180:183], a[232:235], v[164:167], v[180:183]
    s_waitcnt lgkmcnt(10)
    ds_read_b128 v[164:167], v207 offset:2048
    v_mfma_f32_16x16x32_bf16 v[176:179], a[236:239], v[168:171], v[176:179]
    s_waitcnt lgkmcnt(10)
    ds_read_b128 v[168:171], v206 offset:3072
    v_mfma_f32_16x16x32_bf16 v[180:183], a[236:239], v[172:175], v[180:183]
    s_waitcnt lgkmcnt(10)
    ds_read_b128 v[172:175], v207 offset:3072
    v_mfma_f32_16x16x32_bf16 v[176:179], a[240:243], v[144:147], v[176:179]
    s_waitcnt lgkmcnt(10)
    s_waitcnt lgkmcnt(7)
    v_bitop3_b32 v25, v120, v124, 1 bitop3:0x80
    s_waitcnt lgkmcnt(3)
    v_bitop3_b32 v25, v25, v128, v132 bitop3:0x80
    v_mfma_f32_16x16x32_bf16 v[180:183], a[240:243], v[148:151], v[180:183]
    v_cmp_eq_u32 vcc, 0, v25
    v_mfma_f32_16x16x32_bf16 v[176:179], a[244:247], v[152:155], v[176:179]
    v_mfma_f32_16x16x32_bf16 v[180:183], a[244:247], v[156:159], v[180:183]
    s_cbranch_vccnz Lr_o3
Lb_o3:
    v_mfma_f32_16x16x32_bf16 v[176:179], a[248:251], v[160:163], v[176:179]
    s_waitcnt lgkmcnt(2)
    v_mfma_f32_16x16x32_bf16 v[180:183], a[248:251], v[164:167], v[180:183]
    s_waitcnt lgkmcnt(1)
    v_mfma_f32_16x16x32_bf16 v[176:179], a[252:255], v[168:171], v[176:179]
    s_waitcnt lgkmcnt(0)
    s_barrier
    v_mfma_f32_16x16x32_bf16 v[180:183], a[252:255], v[172:175], v[180:183]
    ds_read_b128 v[144:147], v203 offset:16384
    s_add_u32 m0, s66, 0x10c00
    s_add_u32 s65, s57, 0xac00
    v_mfma_f32_16x16x32_bf16 v[184:187], a[192:195], v[104:107], v[184:187]
    ds_read_b128 v[148:151], v203 offset:32768
    v_cvt_pk_bf16_f32 v48, v176, v177
    v_cvt_pk_bf16_f32 v49, v178, v179
    s_nop 0
    v_cvt_pk_bf16_f32 v50, v180, v181
    v_mfma_f32_16x16x32_bf16 v[188:191], a[192:195], v[120:123], v[188:191]
    ds_read_b128 v[152:155], v203 offset:17408
    v_cvt_pk_bf16_f32 v51, v182, v183
    s_add_u32 s50, s93, 0x500000
    v_mfma_f32_16x16x32_bf16 v[184:187], a[196:199], v[108:111], v[184:187]
    ds_read_b128 v[156:159], v203 offset:33792
    v_permlane16_swap_b32 v48, v50
    v_mfma_f32_16x16x32_bf16 v[188:191], a[196:199], v[124:127], v[188:191]
    ds_read_b128 v[160:163], v203 offset:18432
    v_permlane16_swap_b32 v49, v51
    v_bfi_b32 v140, v136, s96, v48
    v_mfma_f32_16x16x32_bf16 v[184:187], a[200:203], v[112:115], v[184:187]
    ds_read_b128 v[164:167], v203 offset:34816
    v_bfi_b32 v142, v138, s96, v50
    v_bfi_b32 v141, v137, s96, v49
    v_bfi_b32 v143, v139, s96, v51
    v_mfma_f32_16x16x32_bf16 v[188:191], a[200:203], v[128:131], v[188:191]
    ds_read_b128 v[168:171], v203 offset:19456
    buffer_store_dwordx4 v[140:143], v18, s[40:43], s50 offen sc1
    v_mfma_f32_16x16x32_bf16 v[184:187], a[204:207], v[116:119], v[184:187]
    ds_read_b128 v[172:175], v203 offset:35840
    v_add_f32 v192, v176, v178
    v_add_f32 v193, v177, v179
    v_mfma_f32_16x16x32_bf16 v[188:191], a[204:207], v[132:135], v[188:191]
    s_waitcnt lgkmcnt(7)
    v_mul_f32 v194, v176, v176
    v_mul_f32 v195, v177, v177
    v_fmac_f32 v194, v178, v178
    v_mfma_f32_16x16x32_bf16 v[184:187], a[208:211], v[144:147], v[184:187]
    s_waitcnt lgkmcnt(6)
    ds_read_b128 v[144:147], v205 offset:16384
    v_fmac_f32 v195, v179, v179
    v_add_f32 v192, v192, v193
    v_mfma_f32_16x16x32_bf16 v[188:191], a[208:211], v[148:151], v[188:191]
    s_waitcnt lgkmcnt(6)
    ds_read_b128 v[148:151], v205 offset:32768
    v_add_f32 v194, v194, v195
    v_add_f32 v196, v180, v182
    v_mfma_f32_16x16x32_bf16 v[184:187], a[212:215], v[152:155], v[184:187]
    s_waitcnt lgkmcnt(6)
    ds_read_b128 v[152:155], v205 offset:17408
    v_add_f32 v197, v181, v183
    v_mul_f32 v198, v180, v180
    v_mfma_f32_16x16x32_bf16 v[188:191], a[212:215], v[156:159], v[188:191]
    s_waitcnt lgkmcnt(6)
    ds_read_b128 v[156:159], v205 offset:33792
    v_mul_f32 v199, v181, v181
    v_fmac_f32 v198, v182, v182
    v_mfma_f32_16x16x32_bf16 v[184:187], a[216:219], v[160:163], v[184:187]
    s_waitcnt lgkmcnt(6)
    ds_read_b128 v[160:163], v205 offset:18432
    v_fmac_f32 v199, v183, v183
    v_add_f32 v196, v196, v197
    v_mfma_f32_16x16x32_bf16 v[188:191], a[216:219], v[164:167], v[188:191]
    s_waitcnt lgkmcnt(6)
    ds_read_b128 v[164:167], v205 offset:34816
    v_add_f32 v198, v198, v199
    v_mfma_f32_16x16x32_bf16 v[184:187], a[220:223], v[168:171], v[184:187]
    s_waitcnt lgkmcnt(6)
    ds_read_b128 v[168:171], v205 offset:19456
    v_permlane32_swap_b32 v192, v194
    v_mfma_f32_16x16x32_bf16 v[188:191], a[220:223], v[172:175], v[188:191]
    s_waitcnt lgkmcnt(6)
    ds_read_b128 v[172:175], v205 offset:35840
    v_permlane32_swap_b32 v196, v198
    v_mfma_f32_16x16x32_bf16 v[184:187], a[224:227], v[144:147], v[184:187]
    s_waitcnt lgkmcnt(6)
    ds_read_b128 v[144:147], v207 offset:16384
    v_add_f32 v192, v192, v194
    v_add_f32 v196, v196, v198
    v_mfma_f32_16x16x32_bf16 v[188:191], a[224:227], v[148:151], v[188:191]
    s_waitcnt lgkmcnt(6)
    ds_read_b128 v[148:151], v207 offset:32768
    v_permlane16_swap_b32 v192, v196
    v_mfma_f32_16x16x32_bf16 v[184:187], a[228:231], v[152:155], v[184:187]
    s_waitcnt lgkmcnt(6)
    ds_read_b128 v[152:155], v207 offset:17408
    v_add_f32 v208, v192, v196
    v_mfma_f32_16x16x32_bf16 v[188:191], a[228:231], v[156:159], v[188:191]
    s_waitcnt lgkmcnt(6)
    ds_read_b128 v[156:159], v207 offset:33792
    v_mfma_f32_16x16x32_bf16 v[184:187], a[232:235], v[160:163], v[184:187]
    s_waitcnt lgkmcnt(6)
    ds_read_b128 v[160:163], v207 offset:18432
    v_mfma_f32_16x16x32_bf16 v[188:191], a[232:235], v[164:167], v[188:191]
    s_waitcnt lgkmcnt(6)
    ds_read_b128 v[164:167], v207 offset:34816
    v_mfma_f32_16x16x32_bf16 v[184:187], a[236:239], v[168:171], v[184:187]
    s_waitcnt lgkmcnt(6)
    ds_read_b128 v[168:171], v207 offset:19456
    v_mfma_f32_16x16x32_bf16 v[188:191], a[236:239], v[172:175], v[188:191]
    s_waitcnt lgkmcnt(6)
    ds_read_b128 v[172:175], v207 offset:35840
    v_mfma_f32_16x16x32_bf16 v[184:187], a[240:243], v[144:147], v[184:187]
    s_waitcnt lgkmcnt(6)
    s_lshl_b32 s68, s3, 9
    s_add_u32 s68, s68, 0x26000
    v_lshl_add_u32 v20, v0, 2, s68
    v_mfma_f32_16x16x32_bf16 v[188:191], a[240:243], v[148:151], v[188:191]
    s_waitcnt lgkmcnt(5)
    s_and_b32 s68, s3, 1
    s_lshl_b32 s68, s68, 8
    s_add_u32 s68, s68, 0x26000
    v_lshl_add_u32 v22, v0, 2, s68
    v_mfma_f32_16x16x32_bf16 v[184:187], a[244:247], v[152:155], v[184:187]
    s_waitcnt lgkmcnt(4)
    v_lshlrev_b32 v21, 2, v0
    v_mov_b32 v252, v28
    v_mov_b32 v253, v28
    v_mfma_f32_16x16x32_bf16 v[188:191], a[244:247], v[156:159], v[188:191]
    s_waitcnt lgkmcnt(3)
    v_mov_b32 v254, v28
    v_mov_b32 v255, v28
    v_mfma_f32_16x16x32_bf16 v[184:187], a[248:251], v[160:163], v[184:187]
    s_waitcnt lgkmcnt(2)
    buffer_load_dwordx4 v32, s[24:27], s65 offen offset:0 lds
    v_mfma_f32_16x16x32_bf16 v[188:191], a[248:251], v[164:167], v[188:191]
    s_waitcnt lgkmcnt(1)
    buffer_load_dwordx4 v33, s[24:27], s65 offen offset:1024 lds
    v_mfma_f32_16x16x32_bf16 v[184:187], a[252:255], v[168:171], v[184:187]
    s_waitcnt lgkmcnt(0)
    buffer_load_dwordx4 v34, s[24:27], s65 offen offset:2048 lds
    v_mfma_f32_16x16x32_bf16 v[188:191], a[252:255], v[172:175], v[188:191]
    s_nop 4
    v_cvt_pk_bf16_f32 v52, v184, v185
    v_cvt_pk_bf16_f32 v53, v186, v187
    s_nop 0
    v_cvt_pk_bf16_f32 v54, v188, v189
    v_cvt_pk_bf16_f32 v55, v190, v191
    s_add_u32 s50, s93, 0x508000
    v_permlane16_swap_b32 v52, v54
    v_permlane16_swap_b32 v53, v55
    v_bfi_b32 v140, v136, s96, v52
    v_bfi_b32 v142, v138, s96, v54
    v_bfi_b32 v141, v137, s96, v53
    v_bfi_b32 v143, v139, s96, v55
    buffer_store_dwordx4 v[140:143], v18, s[40:43], s50 offen sc1
    s_add_u32 m0, s66, 0x11800
    s_add_u32 s65, s57, 0x15800
    buffer_load_dwordx4 v32, s[24:27], s65 offen offset:0 lds
    buffer_load_dwordx4 v33, s[24:27], s65 offen offset:1024 lds
    buffer_load_dwordx4 v34, s[24:27], s65 offen offset:2048 lds
    s_add_u32 m0, s66, 0x12400
    s_add_u32 s65, s57, 0x20400
    buffer_load_dwordx4 v32, s[24:27], s65 offen offset:0 lds
    buffer_load_dwordx4 v33, s[24:27], s65 offen offset:1024 lds
    buffer_load_dwordx4 v34, s[24:27], s65 offen offset:2048 lds
    s_waitcnt vmcnt(14)
    s_barrier
    v_subrev_u32 v44, 0x10000, v44
    v_subrev_u32 v45, 0x10000, v45
    v_pk_add_f32 v[192:193], v[184:185], v[186:187] op_sel:[0,0] op_sel_hi:[1,1]
    v_subrev_u32 v46, 0x10000, v46
    ds_read_b64_tr_b16 a[96:97], v44 offset:0
    v_pk_mul_f32 v[194:195], v[184:185], v[184:185] op_sel:[0,0] op_sel_hi:[1,1]
    ds_read_b64_tr_b16 a[98:99], v44 offset:768
    v_pk_fma_f32 v[194:195], v[186:187], v[186:187], v[194:195] op_sel:[0,0,0] op_sel_hi:[1,1,1]
    ds_read_b64_tr_b16 a[100:101], v45 offset:0
    ds_read_b64_tr_b16 a[102:103], v45 offset:768
    v_add_f32 v192, v192, v193
    ds_read_b64_tr_b16 a[104:105], v46 offset:0
    v_add_f32 v194, v194, v195
    ds_read_b64_tr_b16 a[106:107], v46 offset:768
    ds_read_b64_tr_b16 a[108:109], v44 offset:6144
    v_pk_add_f32 v[196:197], v[188:189], v[190:191] op_sel:[0,0] op_sel_hi:[1,1]
    ds_read_b64_tr_b16 a[110:111], v44 offset:6912
    ds_read_b64_tr_b16 a[112:113], v45 offset:6144
    v_pk_mul_f32 v[198:199], v[188:189], v[188:189] op_sel:[0,0] op_sel_hi:[1,1]
    ds_read_b64_tr_b16 a[114:115], v45 offset:6912
    v_pk_fma_f32 v[198:199], v[190:191], v[190:191], v[198:199] op_sel:[0,0,0] op_sel_hi:[1,1,1]
    ds_read_b64_tr_b16 a[116:117], v46 offset:6144
    ds_read_b64_tr_b16 a[118:119], v46 offset:6912
    v_add_f32 v196, v196, v197
    ds_read_b64_tr_b16 a[120:121], v44 offset:24576
    v_add_f32 v198, v198, v199
    ds_read_b64_tr_b16 a[122:123], v44 offset:25344
    ds_read_b64_tr_b16 a[124:125], v45 offset:24576
    v_permlane32_swap_b32 v192, v194
    ds_read_b64_tr_b16 a[126:127], v45 offset:25344
    ds_read_b64_tr_b16 a[128:129], v46 offset:24576
    v_permlane32_swap_b32 v196, v198
    ds_read_b64_tr_b16 a[130:131], v46 offset:25344
    v_add_f32 v192, v192, v194
    ds_read_b64_tr_b16 a[132:133], v44 offset:30720
    ds_read_b64_tr_b16 a[134:135], v44 offset:31488
    v_add_f32 v196, v196, v198
    ds_read_b64_tr_b16 a[136:137], v45 offset:30720
    s_nop 0
    v_permlane16_swap_b32 v192, v196
    ds_read_b64_tr_b16 a[138:139], v45 offset:31488
    ds_read_b64_tr_b16 a[140:141], v46 offset:30720
    v_add_f32 v209, v192, v196
    ds_read_b64_tr_b16 a[142:143], v46 offset:31488
    ds_write2st64_b32 v20, v208, v209 offset0:0 offset1:1
    s_waitcnt lgkmcnt(0)
    s_barrier
    ds_read2st64_b32 v[192:193], v22 offset0:0 offset1:2
    ds_read2st64_b32 v[194:195], v22 offset0:4 offset1:6
    s_waitcnt lgkmcnt(0)
    v_pk_add_f32 v[192:193], v[192:193], v[194:195] op_sel:[0,0] op_sel_hi:[1,1]
    v_add_f32 v192, v192, v193
    v_bfi_b32 v192, 3, v41, v192
    buffer_store_dword v192, v21, s[40:43], s94 offen sc1
    s_mul_i32 s68, s97, 0x2c00
    s_add_u32 s68, s68, 0x180
    v_lshlrev_b32 v68, 10, v0
    s_mov_b64 exec, 0x7ff
    buffer_load_dword v69, v68, s[28:31], s68 offen
    s_mov_b64 exec, -1
    s_add_u32 m0, s63, 0
    s_add_u32 s65, s48, 0
    buffer_load_dwordx4 v6, s[28:31], s65 offen offset:0 lds
    buffer_load_dwordx4 v7, s[28:31], s65 offen offset:1024 lds
    buffer_load_dwordx4 v8, s[28:31], s65 offen offset:2048 lds
    buffer_load_dwordx4 v9, s[28:31], s65 offen offset:3072 lds
    v_mfma_f32_16x16x32_bf16 v[56:59], a[96:99], v[28:31], v[56:59]
    v_mfma_f32_16x16x32_bf16 v[60:63], a[100:103], v[28:31], v[60:63]
    v_mfma_f32_16x16x32_bf16 v[64:67], a[104:107], v[28:31], v[64:67]
    v_mfma_f32_16x16x32_bf16 v[56:59], a[108:111], v[28:31], v[56:59]
    v_mfma_f32_16x16x32_bf16 v[60:63], a[112:115], v[28:31], v[60:63]
    v_mfma_f32_16x16x32_bf16 v[64:67], a[116:119], v[28:31], v[64:67]
    v_mfma_f32_16x16x32_bf16 v[56:59], a[120:123], v[28:31], v[56:59]
    v_mfma_f32_16x16x32_bf16 v[60:63], a[124:127], v[28:31], v[60:63]
    v_mfma_f32_16x16x32_bf16 v[64:67], a[128:131], v[28:31], v[64:67]
    v_mfma_f32_16x16x32_bf16 v[56:59], a[132:135], v[28:31], v[56:59]
    v_mfma_f32_16x16x32_bf16 v[60:63], a[136:139], v[28:31], v[60:63]
    v_mfma_f32_16x16x32_bf16 v[64:67], a[140:143], v[28:31], v[64:67]
    s_waitcnt vmcnt(6)
    s_barrier
    s_add_u32 m0, s63, 0xc000
    s_add_u32 s65, s92, 0
    buffer_load_dwordx4 v1, s[40:43], s65 offen offset:0 sc1 lds
    buffer_load_dwordx4 v1, s[40:43], s65 offen offset:1024 sc1 lds
    buffer_load_dwordx4 v1, s[40:43], s65 offen offset:2048 sc1 lds
    buffer_load_dwordx4 v1, s[40:43], s65 offen offset:3072 sc1 lds
    s_add_u32 m0, s63, 0x1c000
    s_add_u32 s65, s92, 0x4000
    buffer_load_dwordx4 v1, s[40:43], s65 offen offset:0 sc1 lds
    buffer_load_dwordx4 v1, s[40:43], s65 offen offset:1024 sc1 lds
    buffer_load_dwordx4 v1, s[40:43], s65 offen offset:2048 sc1 lds
    buffer_load_dwordx4 v1, s[40:43], s65 offen offset:3072 sc1 lds
    s_add_u32 m0, s63, 0x4000
    s_add_u32 s65, s48, 0x8000
    buffer_load_dwordx4 v6, s[28:31], s65 offen offset:0 lds
    buffer_load_dwordx4 v7, s[28:31], s65 offen offset:1024 lds
    buffer_load_dwordx4 v8, s[28:31], s65 offen offset:2048 lds
    buffer_load_dwordx4 v9, s[28:31], s65 offen offset:3072 lds
    v_add_u32 v44, 0x10000, v44
    v_add_u32 v45, 0x10000, v45
    v_add_u32 v46, 0x10000, v46
    ds_read_b64_tr_b16 a[144:145], v44 offset:0
    ds_read_b64_tr_b16 a[146:147], v44 offset:768
    ds_read_b64_tr_b16 a[148:149], v45 offset:0
    ds_read_b64_tr_b16 a[150:151], v45 offset:768
    ds_read_b64_tr_b16 a[152:153], v46 offset:0
    ds_read_b64_tr_b16 a[154:155], v46 offset:768
    ds_read_b64_tr_b16 a[156:157], v44 offset:6144
    ds_read_b64_tr_b16 a[158:159], v44 offset:6912
    ds_read_b64_tr_b16 a[160:161], v45 offset:6144
    ds_read_b64_tr_b16 a[162:163], v45 offset:6912
    ds_read_b64_tr_b16 a[164:165], v46 offset:6144
    ds_read_b64_tr_b16 a[166:167], v46 offset:6912
    ds_read_b64_tr_b16 a[168:169], v44 offset:24576
    ds_read_b64_tr_b16 a[170:171], v44 offset:25344
    ds_read_b64_tr_b16 a[172:173], v45 offset:24576
    ds_read_b64_tr_b16 a[174:175], v45 offset:25344
    ds_read_b64_tr_b16 a[176:177], v46 offset:24576
    ds_read_b64_tr_b16 a[178:179], v46 offset:25344
    ds_read_b64_tr_b16 a[180:181], v44 offset:30720
    ds_read_b64_tr_b16 a[182:183], v44 offset:31488
    ds_read_b64_tr_b16 a[184:185], v45 offset:30720
    ds_read_b64_tr_b16 a[186:187], v45 offset:31488
    ds_read_b64_tr_b16 a[188:189], v46 offset:30720
    ds_read_b64_tr_b16 a[190:191], v46 offset:31488
    s_waitcnt lgkmcnt(15)
    v_mfma_f32_16x16x32_bf16 v[56:59], a[144:147], v[28:31], v[56:59]
    v_mfma_f32_16x16x32_bf16 v[60:63], a[148:151], v[28:31], v[60:63]
    v_mfma_f32_16x16x32_bf16 v[64:67], a[152:155], v[28:31], v[64:67]
    v_mfma_f32_16x16x32_bf16 v[56:59], a[156:159], v[28:31], v[56:59]
    s_waitcnt lgkmcnt(14)
    v_mfma_f32_16x16x32_bf16 v[60:63], a[160:163], v[28:31], v[60:63]
    s_waitcnt lgkmcnt(12)
    v_mfma_f32_16x16x32_bf16 v[64:67], a[164:167], v[28:31], v[64:67]
    s_waitcnt lgkmcnt(10)
    v_mfma_f32_16x16x32_bf16 v[56:59], a[168:171], v[28:31], v[56:59]
    s_waitcnt lgkmcnt(8)
    v_mfma_f32_16x16x32_bf16 v[60:63], a[172:175], v[28:31], v[60:63]
    s_waitcnt lgkmcnt(6)
    v_mfma_f32_16x16x32_bf16 v[64:67], a[176:179], v[28:31], v[64:67]
    s_waitcnt lgkmcnt(4)
    v_mfma_f32_16x16x32_bf16 v[56:59], a[180:183], v[28:31], v[56:59]
    s_waitcnt lgkmcnt(2)
    v_mfma_f32_16x16x32_bf16 v[60:63], a[184:187], v[28:31], v[60:63]
    s_waitcnt lgkmcnt(0)
    v_mfma_f32_16x16x32_bf16 v[64:67], a[188:191], v[28:31], v[64:67]
    s_waitcnt vmcnt(8)
    ds_read2st64_b32 v[248:249], v19 offset0:0 offset1:4
    ds_read2st64_b32 v[250:251], v19 offset0:8 offset1:12
    s_waitcnt lgkmcnt(0)
    v_bitop3_b32 v26, v248, v249, s96 bitop3:0x7e
    v_bitop3_b32 v26, v26, v250, s96 bitop3:0xf6
    v_bitop3_b32 v26, v26, v251, s96 bitop3:0xf6
    v_and_b32 v26, s1, v26
    v_cmp_ne_u32 vcc, 0, v26
    s_cbranch_vccnz Lr_h0
Lb_h0:
    s_barrier
    ds_read_b128 v[144:147], v27 offset:0
    ds_read_b128 v[148:151], v27 offset:8192
    ds_read_b128 v[152:155], v27 offset:4096
    ds_read_b128 v[156:159], v27 offset:12288
    s_waitcnt lgkmcnt(3)
    v_mfma_f32_16x16x32_bf16 v[72:75], a[0:3], v[144:147], 0
    ds_read_b128 v[160:163], v27 offset:1024
    s_add_u32 m0, s63, 0x20000
    s_add_u32 s65, s58, 0
    buffer_load_dwordx4 v1, s[40:43], s65 offen offset:0 sc1 lds
    v_mfma_f32_16x16x32_bf16 v[76:79], a[4:7], v[144:147], 0
    s_mul_i32 s93, s4, 0x2d000
    s_mul_i32 s52, s3, 0x2c00
    s_add_u32 s93, s93, s52
    v_mfma_f32_16x16x32_bf16 v[80:83], a[8:11], v[144:147], 0
    s_waitcnt lgkmcnt(3)
    s_add_u32 s93, s93, 0x800000
    v_mfma_f32_16x16x32_bf16 v[84:87], a[0:3], v[148:151], 0
    ds_read_b128 v[164:167], v27 offset:9216
    v_mfma_f32_16x16x32_bf16 v[88:91], a[4:7], v[148:151], 0
    buffer_load_dwordx4 v1, s[40:43], s65 offen offset:1024 sc1 lds
    v_mfma_f32_16x16x32_bf16 v[92:95], a[8:11], v[148:151], 0
    s_waitcnt lgkmcnt(3)
    v_mfma_f32_16x16x32_bf16 v[72:75], a[48:51], v[152:155], v[72:75]
    ds_read_b128 v[144:147], v27 offset:5120
    v_mfma_f32_16x16x32_bf16 v[76:79], a[52:55], v[152:155], v[76:79]
    v_mfma_f32_16x16x32_bf16 v[80:83], a[56:59], v[152:155], v[80:83]
    s_waitcnt lgkmcnt(3)
    buffer_load_dwordx4 v1, s[40:43], s65 offen offset:2048 sc1 lds
    v_mfma_f32_16x16x32_bf16 v[84:87], a[48:51], v[156:159], v[84:87]
    ds_read_b128 v[148:151], v27 offset:13312
    v_mfma_f32_16x16x32_bf16 v[88:91], a[52:55], v[156:159], v[88:91]
    v_mfma_f32_16x16x32_bf16 v[92:95], a[56:59], v[156:159], v[92:95]
    s_waitcnt lgkmcnt(3)
    v_mfma_f32_16x16x32_bf16 v[72:75], a[12:15], v[160:163], v[72:75]
    ds_read_b128 v[152:155], v27 offset:2048
    buffer_load_dwordx4 v1, s[40:43], s65 offen offset:3072 sc1 lds
    v_mfma_f32_16x16x32_bf16 v[76:79], a[16:19], v[160:163], v[76:79]
    v_mfma_f32_16x16x32_bf16 v[80:83], a[20:23], v[160:163], v[80:83]
    s_waitcnt lgkmcnt(3)
    v_mfma_f32_16x16x32_bf16 v[84:87], a[12:15], v[164:167], v[84:87]
    ds_read_b128 v[156:159], v27 offset:10240
    s_add_u32 m0, s63, 0x24000
    v_mfma_f32_16x16x32_bf16 v[88:91], a[16:19], v[164:167], v[88:91]
    s_add_u32 s65, s58, 0x4000
    buffer_load_dwordx4 v1, s[40:43], s65 offen offset:0 sc1 lds
    v_mfma_f32_16x16x32_bf16 v[92:95], a[20:23], v[164:167], v[92:95]
    s_waitcnt lgkmcnt(3)
    v_mfma_f32_16x16x32_bf16 v[72:75], a[60:63], v[144:147], v[72:75]
    ds_read_b128 v[160:163], v27 offset:6144
    s_waitcnt vmcnt(9)
    v_mfma_f32_16x16x32_bf16 v[76:79], a[64:67], v[144:147], v[76:79]
    ds_read2st64_b32 v[248:249], v42 offset0:0 offset1:4
    v_mfma_f32_16x16x32_bf16 v[80:83], a[68:71], v[144:147], v[80:83]
    s_waitcnt lgkmcnt(4)
    ds_read2st64_b32 v[250:251], v42 offset0:8 offset1:12
    v_mfma_f32_16x16x32_bf16 v[84:87], a[60:63], v[148:151], v[84:87]
    ds_read_b128 v[164:167], v27 offset:14336
    buffer_load_dwordx4 v1, s[40:43], s65 offen offset:1024 sc1 lds
    v_mfma_f32_16x16x32_bf16 v[88:91], a[64:67], v[148:151], v[88:91]
    ds_read_b64_tr_b16 a[192:193], v10 offset:0
    v_mfma_f32_16x16x32_bf16 v[92:95], a[68:71], v[148:151], v[92:95]
    s_waitcnt lgkmcnt(6)
    ds_read_b64_tr_b16 a[194:195], v10 offset:512
    v_mfma_f32_16x16x32_bf16 v[72:75], a[24:27], v[152:155], v[72:75]
    ds_read_b128 v[144:147], v27 offset:3072
    s_waitcnt lgkmcnt(5)
    v_bitop3_b32 v26, v248, v249, s96 bitop3:0x7e
    v_mfma_f32_16x16x32_bf16 v[76:79], a[28:31], v[152:155], v[76:79]
    s_waitcnt lgkmcnt(4)
    v_bitop3_b32 v26, v26, v250, s96 bitop3:0xf6
    v_bitop3_b32 v26, v26, v251, s96 bitop3:0xf6
    buffer_load_dwordx4 v1, s[40:43], s65 offen offset:2048 sc1 lds
    v_mfma_f32_16x16x32_bf16 v[80:83], a[32:35], v[152:155], v[80:83]
    v_and_b32 v26, s1, v26
    v_cmp_ne_u32 vcc, 0, v26
    v_mfma_f32_16x16x32_bf16 v[84:87], a[24:27], v[156:159], v[84:87]
    ds_read_b128 v[148:151], v27 offset:11264
    v_mfma_f32_16x16x32_bf16 v[88:91], a[28:31], v[156:159], v[88:91]
    s_cbranch_vccnz Lr_h1
Lb_h1:
    v_mfma_f32_16x16x32_bf16 v[92:95], a[32:35], v[156:159], v[92:95]
    buffer_load_dwordx4 v1, s[40:43], s65 offen offset:3072 sc1 lds
    v_mfma_f32_16x16x32_bf16 v[72:75], a[72:75], v[160:163], v[72:75]
    ds_read_b128 v[152:155], v27 offset:7168
    v_mfma_f32_16x16x32_bf16 v[76:79], a[76:79], v[160:163], v[76:79]
    ds_read_b64_tr_b16 a[196:197], v11 offset:0
    v_mfma_f32_16x16x32_bf16 v[80:83], a[80:83], v[160:163], v[80:83]
    s_waitcnt lgkmcnt(6)
    s_lshl_b32 s51, s6, 13
    s_lshr_b32 s52, s3, 1
    s_lshl_b32 s52, s52, 12
    s_add_u32 s51, s51, s52
    s_and_b32 s52, s3, 1
    v_mfma_f32_16x16x32_bf16 v[84:87], a[72:75], v[164:167], v[84:87]
    ds_read_b128 v[156:159], v27 offset:15360
    s_lshl_b32 s52, s52, 8
    s_add_u32 s51, s51, s52
    s_add_u32 s51, s51, 0x2e0000
    buffer_load_dword v220, v21, s[40:43], s51 offen offset:0 sc1
    v_mfma_f32_16x16x32_bf16 v[88:91], a[76:79], v[164:167], v[88:91]
    s_barrier
    v_mfma_f32_16x16x32_bf16 v[92:95], a[80:83], v[164:167], v[92:95]
    s_waitcnt lgkmcnt(4)
    ds_read_b64_tr_b16 a[198:199], v11 offset:512
    v_mfma_f32_16x16x32_bf16 v[72:75], a[36:39], v[144:147], v[72:75]
    ds_read_b128 v[160:163], v40 offset:0
    v_mfma_f32_16x16x32_bf16 v[76:79], a[40:43], v[144:147], v[76:79]
    buffer_load_dword v221, v21, s[40:43], s51 offen offset:512 sc1
    v_mfma_f32_16x16x32_bf16 v[80:83], a[44:47], v[144:147], v[80:83]
    s_waitcnt lgkmcnt(5)
    ds_read_b64_tr_b16 a[200:201], v12 offset:0
    v_mfma_f32_16x16x32_bf16 v[84:87], a[36:39], v[148:151], v[84:87]
    ds_read_b128 v[164:167], v40 offset:8192
    v_mfma_f32_16x16x32_bf16 v[88:91], a[40:43], v[148:151], v[88:91]
    ds_read_b64_tr_b16 a[202:203], v12 offset:512
    v_mfma_f32_16x16x32_bf16 v[92:95], a[44:47], v[148:151], v[92:95]
    s_waitcnt lgkmcnt(7)
    ds_read_b64_tr_b16 a[204:205], v13 offset:0
    v_mfma_f32_16x16x32_bf16 v[72:75], a[84:87], v[152:155], v[72:75]
    ds_read_b128 v[144:147], v40 offset:4096
    buffer_load_dword v222, v21, s[40:43], s51 offen offset:1024 sc1
    v_mfma_f32_16x16x32_bf16 v[76:79], a[88:91], v[152:155], v[76:79]
    ds_read_b64_tr_b16 a[206:207], v13 offset:512
    s_waitcnt vmcnt(11)
    v_mfma_f32_16x16x32_bf16 v[80:83], a[92:95], v[152:155], v[80:83]
    s_waitcnt lgkmcnt(8)
    ds_read_b64_tr_b16 a[208:209], v10 offset:16384
    v_mfma_f32_16x16x32_bf16 v[84:87], a[84:87], v[156:159], v[84:87]
    ds_read_b128 v[148:151], v40 offset:12288
    v_mfma_f32_16x16x32_bf16 v[88:91], a[88:91], v[156:159], v[88:91]
    buffer_load_dword v223, v21, s[40:43], s51 offen offset:1536 sc1
    v_mfma_f32_16x16x32_bf16 v[92:95], a[92:95], v[156:159], v[92:95]
    s_waitcnt lgkmcnt(8)
    ds_read_b64_tr_b16 a[210:211], v10 offset:16896
    v_mfma_f32_16x16x32_bf16 v[96:99], a[0:3], v[160:163], 0
    ds_read_b128 v[152:155], v40 offset:1024
    v_mfma_f32_16x16x32_bf16 v[100:103], a[4:7], v[160:163], 0
    ds_read_b64_tr_b16 a[212:213], v11 offset:16384
    v_mfma_f32_16x16x32_bf16 v[104:107], a[8:11], v[160:163], 0
    s_waitcnt lgkmcnt(9)
    buffer_load_dword v224, v21, s[40:43], s51 offen offset:2048 sc1
    v_mfma_f32_16x16x32_bf16 v[108:111], a[0:3], v[164:167], 0
    ds_read_b128 v[156:159], v40 offset:9216
    v_mfma_f32_16x16x32_bf16 v[112:115], a[4:7], v[164:167], 0
    ds_read_b64_tr_b16 a[214:215], v11 offset:16896
    v_mfma_f32_16x16x32_bf16 v[116:119], a[8:11], v[164:167], 0
    s_waitcnt lgkmcnt(8)
    ds_read_b64_tr_b16 a[216:217], v12 offset:16384
    v_mfma_f32_16x16x32_bf16 v[96:99], a[48:51], v[144:147], v[96:99]
    ds_read_b128 v[160:163], v40 offset:5120
    buffer_load_dword v225, v21, s[40:43], s51 offen offset:2560 sc1
    v_mfma_f32_16x16x32_bf16 v[100:103], a[52:55], v[144:147], v[100:103]
    ds_read_b64_tr_b16 a[218:219], v12 offset:16896
    v_mfma_f32_16x16x32_bf16 v[104:107], a[56:59], v[144:147], v[104:107]
    s_waitcnt lgkmcnt(8)
    v_mfma_f32_16x16x32_bf16 v[108:111], a[48:51], v[148:151], v[108:111]
    ds_read_b128 v[164:167], v40 offset:13312
    v_mfma_f32_16x16x32_bf16 v[112:115], a[52:55], v[148:151], v[112:115]
    buffer_load_dword v226, v21, s[40:43], s51 offen offset:3072 sc1
    v_mfma_f32_16x16x32_bf16 v[116:119], a[56:59], v[148:151], v[116:119]
    s_waitcnt lgkmcnt(7)
    ds_read_b64_tr_b16 a[220:221], v13 offset:16384
    v_mfma_f32_16x16x32_bf16 v[96:99], a[12:15], v[152:155], v[96:99]
    ds_read_b128 v[144:147], v40 offset:2048
    v_mfma_f32_16x16x32_bf16 v[100:103], a[16:19], v[152:155], v[100:103]
    ds_read_b64_tr_b16 a[222:223], v13 offset:16896
    v_mfma_f32_16x16x32_bf16 v[104:107], a[20:23], v[152:155], v[104:107]
    s_waitcnt lgkmcnt(8)
    v_mfma_f32_16x16x32_bf16 v[108:111], a[12:15], v[156:159], v[108:111]
    ds_read_b128 v[148:151], v40 offset:10240
    buffer_load_dword v227, v21, s[40:43], s51 offen offset:3584 sc1
    v_mfma_f32_16x16x32_bf16 v[112:115], a[16:19], v[156:159], v[112:115]
    v_mfma_f32_16x16x32_bf16 v[116:119], a[20:23], v[156:159], v[116:119]
    s_waitcnt lgkmcnt(6)
    v_mfma_f32_16x16x32_bf16 v[96:99], a[60:63], v[160:163], v[96:99]
    ds_read_b128 v[152:155], v40 offset:6144
    s_waitcnt vmcnt(12)
    s_add_u32 m0, s63, 0x8000
    v_mfma_f32_16x16x32_bf16 v[100:103], a[64:67], v[160:163], v[100:103]
    ds_read2st64_b32 v[248:249], v42 offset0:64 offset1:68
    s_add_u32 s65, s48, 0x10000
    buffer_load_dwordx4 v6, s[28:31], s65 offen offset:0 lds
    v_mfma_f32_16x16x32_bf16 v[104:107], a[68:71], v[160:163], v[104:107]
    s_waitcnt lgkmcnt(6)
    ds_read2st64_b32 v[250:251], v42 offset0:72 offset1:76
    v_mfma_f32_16x16x32_bf16 v[108:111], a[60:63], v[164:167], v[108:111]
    ds_read_b128 v[156:159], v40 offset:14336
    v_mfma_f32_16x16x32_bf16 v[112:115], a[64:67], v[164:167], v[112:115]
    v_mfma_f32_16x16x32_bf16 v[116:119], a[68:71], v[164:167], v[116:119]
    s_waitcnt lgkmcnt(6)
    buffer_load_dwordx4 v7, s[28:31], s65 offen offset:1024 lds
    v_mfma_f32_16x16x32_bf16 v[96:99], a[24:27], v[144:147], v[96:99]
    ds_read_b128 v[160:163], v40 offset:3072
    s_waitcnt lgkmcnt(3)
    v_bitop3_b32 v26, v248, v249, s96 bitop3:0x7e
    v_mfma_f32_16x16x32_bf16 v[100:103], a[28:31], v[144:147], v[100:103]
    s_waitcnt lgkmcnt(2)
    v_bitop3_b32 v26, v26, v250, s96 bitop3:0xf6
    v_bitop3_b32 v26, v26, v251, s96 bitop3:0xf6
    v_mfma_f32_16x16x32_bf16 v[104:107], a[32:35], v[144:147], v[104:107]
    v_and_b32 v26, s1, v26
    v_cmp_ne_u32 vcc, 0, v26
    v_mfma_f32_16x16x32_bf16 v[108:111], a[24:27], v[148:151], v[108:111]
    ds_read_b128 v[164:167], v40 offset:11264
    buffer_load_dwordx4 v8, s[28:31], s65 offen offset:2048 lds
    v_mfma_f32_16x16x32_bf16 v[112:115], a[28:31], v[148:151], v[112:115]
    s_cbranch_vccnz Lr_h2
Lb_h2:
    v_mfma_f32_16x16x32_bf16 v[116:119], a[32:35], v[148:151], v[116:119]
    v_mfma_f32_16x16x32_bf16 v[96:99], a[72:75], v[152:155], v[96:99]
    ds_read_b128 v[144:147], v40 offset:7168
    v_mfma_f32_16x16x32_bf16 v[100:103], a[76:79], v[152:155], v[100:103]
    buffer_load_dwordx4 v9, s[28:31], s65 offen offset:3072 lds
    v_mfma_f32_16x16x32_bf16 v[104:107], a[80:83], v[152:155], v[104:107]
    s_waitcnt lgkmcnt(3)
    v_mfma_f32_16x16x32_bf16 v[108:111], a[72:75], v[156:159], v[108:111]
    ds_read_b128 v[148:151], v40 offset:15360
    v_mfma_f32_16x16x32_bf16 v[112:115], a[76:79], v[156:159], v[112:115]
    s_barrier
    v_mfma_f32_16x16x32_bf16 v[116:119], a[80:83], v[156:159], v[116:119]
    s_waitcnt lgkmcnt(3)
    s_add_u32 m0, s63, 0x10000
    s_add_u32 s65, s48, 0x18000
    v_mfma_f32_16x16x32_bf16 v[96:99], a[36:39], v[160:163], v[96:99]
    ds_read_b128 v[152:155], v40 offset:16384
    buffer_load_dwordx4 v6, s[28:31], s65 offen offset:0 lds
    v_mfma_f32_16x16x32_bf16 v[100:103], a[40:43], v[160:163], v[100:103]
    s_mul_i32 s68, s3, 0x1800
    s_add_u32 s68, s68, 0x20000
    v_add_u32 v5, s68, v1
    v_mfma_f32_16x16x32_bf16 v[104:107], a[44:47], v[160:163], v[104:107]
    s_waitcnt lgkmcnt(3)
    s_add_u32 s68, s3, 1
    s_and_b32 s68, s68, 3
    s_mul_i32 s68, s68, 0x1800
    v_add_u32 v2, s68, v1
    v_mfma_f32_16x16x32_bf16 v[108:111], a[36:39], v[164:167], v[108:111]
    ds_read_b128 v[156:159], v40 offset:24576
    v_add_u32 v2, 0x20000, v2
    v_mfma_f32_16x16x32_bf16 v[112:115], a[40:43], v[164:167], v[112:115]
    buffer_load_dwordx4 v7, s[28:31], s65 offen offset:1024 lds
    v_mfma_f32_16x16x32_bf16 v[116:119], a[44:47], v[164:167], v[116:119]
    s_waitcnt lgkmcnt(3)
    s_add_u32 s68, s3, 2
    s_and_b32 s68, s68, 3
    s_mul_i32 s68, s68, 0x1800
    v_add_u32 v3, s68, v1
    v_mfma_f32_16x16x32_bf16 v[96:99], a[84:87], v[144:147], v[96:99]
    ds_read_b128 v[160:163], v40 offset:20480
    v_add_u32 v3, 0x20000, v3
    v_and_b32 v229, 3, v41
    s_waitcnt vmcnt(13)
    v_xor_b32 v220, v229, v220
    v_mfma_f32_16x16x32_bf16 v[100:103], a[88:91], v[144:147], v[100:103]
    s_add_u32 s68, s3, 3
    s_and_b32 s68, s68, 3
    s_mul_i32 s68, s68, 0x1800
    v_add_u32 v4, s68, v1
    s_waitcnt vmcnt(12)
    v_xor_b32 v221, v229, v221
    v_mfma_f32_16x16x32_bf16 v[104:107], a[92:95], v[144:147], v[104:107]
    s_waitcnt lgkmcnt(3)
    buffer_load_dwordx4 v8, s[28:31], s65 offen offset:2048 lds
    s_waitcnt vmcnt(12)
    v_xor_b32 v222, v229, v222
    v_mfma_f32_16x16x32_bf16 v[108:111], a[84:87], v[148:151], v[108:111]
    ds_read_b128 v[164:167], v40 offset:28672
    v_add_u32 v4, 0x20000, v4
    s_waitcnt vmcnt(11)
    v_xor_b32 v223, v229, v223
    s_waitcnt vmcnt(10)
    v_xor_b32 v224, v229, v224
    v_mfma_f32_16x16x32_bf16 v[112:115], a[88:91], v[148:151], v[112:115]
    s_waitcnt vmcnt(9)
    v_xor_b32 v225, v229, v225
    s_waitcnt vmcnt(8)
    v_xor_b32 v226, v229, v226
    s_waitcnt vmcnt(7)
    v_xor_b32 v227, v229, v227
    v_or3_b32 v228, v220, v221, v222
    v_mfma_f32_16x16x32_bf16 v[116:119], a[92:95], v[148:151], v[116:119]
    s_waitcnt lgkmcnt(3)
    v_or3_b32 v228, v228, v223, v224
    v_or3_b32 v228, v228, v225, v226
    v_bitop3_b32 v228, v228, v227, 3 bitop3:0xa8
    v_cmp_ne_u32 vcc, 0, v228
    v_mfma_f32_16x16x32_bf16 v[72:75], a[96:99], v[152:155], v[72:75]
    ds_read_b128 v[144:147], v40 offset:17408
    buffer_load_dwordx4 v9, s[28:31], s65 offen offset:3072 lds
    v_mfma_f32_16x16x32_bf16 v[76:79], a[100:103], v[152:155], v[76:79]
    s_cbranch_vccnz Lr_st
Lb_st:
    v_add_f32 v220, v220, v222
    v_mfma_f32_16x16x32_bf16 v[80:83], a[104:107], v[152:155], v[80:83]
    s_waitcnt lgkmcnt(3)
    v_add_f32 v221, v221, v223
    v_add_f32 v224, v224, v226
    v_add_f32 v225, v225, v227
    v_add_f32 v220, v220, v224
    v_mfma_f32_16x16x32_bf16 v[84:87], a[96:99], v[156:159], v[84:87]
    ds_read_b128 v[148:151], v40 offset:25600
    s_add_u32 m0, s63, 0xc000
    v_add_f32 v221, v221, v225
    v_add_f32 v220, v220, v221
    v_mfma_f32_16x16x32_bf16 v[88:91], a[100:103], v[156:159], v[88:91]
    s_add_u32 s65, s92, 0x8000
    buffer_load_dwordx4 v1, s[40:43], s65 offen offset:0 sc1 lds
    v_mul_f32 v221, 0x3b000000, v220
    v_mfma_f32_16x16x32_bf16 v[92:95], a[104:107], v[156:159], v[92:95]
    s_waitcnt lgkmcnt(3)
    v_mul_f32 v220, 0x3b000000, v220
    s_lshl_b32 s52, s3, 7
    s_add_u32 s52, s52, 0x18000
    v_and_b32 v21, 31, v0
    v_mfma_f32_16x16x32_bf16 v[72:75], a[144:147], v[160:163], v[72:75]
    ds_read_b128 v[152:155], v40 offset:21504
    v_lshl_add_u32 v21, v21, 2, s52
    v_permlane32_swap_b32 v220, v221
    v_mfma_f32_16x16x32_bf16 v[76:79], a[148:151], v[160:163], v[76:79]
    v_fma_f32 v221, -v220, v220, v221
    v_max_f32 v221, 0, v221
    v_add_f32 v221, 0x3727c5ac, v221
    v_mfma_f32_16x16x32_bf16 v[80:83], a[152:155], v[160:163], v[80:83]
    s_waitcnt lgkmcnt(3)
    v_rcp_f32 v221, v221
    v_sub_f32 v220, 0, v220
    s_mov_b32 s52, 0x18000
    v_mfma_f32_16x16x32_bf16 v[84:87], a[144:147], v[164:167], v[84:87]
    ds_read_b128 v[156:159], v40 offset:29696
    buffer_load_dwordx4 v1, s[40:43], s65 offen offset:1024 sc1 lds
    v_mfma_f32_16x16x32_bf16 v[88:91], a[148:151], v[164:167], v[88:91]
    v_lshl_add_u32 v22, v14, 2, s52
    ds_write2st64_b32 v21, v220, v221 offset0:0 offset1:2
    v_mfma_f32_16x16x32_bf16 v[92:95], a[152:155], v[164:167], v[92:95]
    s_waitcnt lgkmcnt(4)
    s_and_b32 s52, s4, 1
    s_lshl_b32 s52, s52, 8
    v_add_u32 v23, s52, v22
    v_mfma_f32_16x16x32_bf16 v[72:75], a[108:111], v[144:147], v[72:75]
    ds_read_b128 v[160:163], v40 offset:18432
    v_mfma_f32_16x16x32_bf16 v[76:79], a[112:115], v[144:147], v[76:79]
    buffer_load_dwordx4 v1, s[40:43], s65 offen offset:2048 sc1 lds
    v_mfma_f32_16x16x32_bf16 v[80:83], a[116:119], v[144:147], v[80:83]
    s_waitcnt lgkmcnt(4)
    s_waitcnt lgkmcnt(1)
    v_mfma_f32_16x16x32_bf16 v[84:87], a[108:111], v[148:151], v[84:87]
    ds_read_b128 v[164:167], v40 offset:26624
    v_mfma_f32_16x16x32_bf16 v[88:91], a[112:115], v[148:151], v[88:91]
    v_mfma_f32_16x16x32_bf16 v[92:95], a[116:119], v[148:151], v[92:95]
    buffer_load_dwordx4 v1, s[40:43], s65 offen offset:3072 sc1 lds
    v_mfma_f32_16x16x32_bf16 v[72:75], a[156:159], v[152:155], v[72:75]
    ds_read_b128 v[144:147], v40 offset:22528
    v_mfma_f32_16x16x32_bf16 v[76:79], a[160:163], v[152:155], v[76:79]
    ds_read2st64_b32 v[248:249], v42 offset0:128 offset1:132
    v_mfma_f32_16x16x32_bf16 v[80:83], a[164:167], v[152:155], v[80:83]
    ds_read2st64_b32 v[250:251], v42 offset0:136 offset1:140
    s_add_u32 m0, s63, 0x14000
    v_mfma_f32_16x16x32_bf16 v[84:87], a[156:159], v[156:159], v[84:87]
    ds_read_b128 v[148:151], v40 offset:30720
    s_add_u32 s65, s48, 0x20000
    buffer_load_dwordx4 v6, s[28:31], s65 offen offset:0 lds
    v_mfma_f32_16x16x32_bf16 v[88:91], a[160:163], v[156:159], v[88:91]
    v_mfma_f32_16x16x32_bf16 v[92:95], a[164:167], v[156:159], v[92:95]
    s_waitcnt lgkmcnt(5)
    v_mfma_f32_16x16x32_bf16 v[72:75], a[120:123], v[160:163], v[72:75]
    ds_read_b128 v[152:155], v40 offset:19456
    s_waitcnt lgkmcnt(3)
    v_bitop3_b32 v26, v248, v249, s96 bitop3:0x7e
    v_mfma_f32_16x16x32_bf16 v[76:79], a[124:127], v[160:163], v[76:79]
    s_waitcnt lgkmcnt(2)
    v_bitop3_b32 v26, v26, v250, s96 bitop3:0xf6
    v_bitop3_b32 v26, v26, v251, s96 bitop3:0xf6
    buffer_load_dwordx4 v7, s[28:31], s65 offen offset:1024 lds
    v_mfma_f32_16x16x32_bf16 v[80:83], a[128:131], v[160:163], v[80:83]
    v_and_b32 v26, s1, v26
    v_cmp_ne_u32 vcc, 0, v26
    s_waitcnt vmcnt(10)
    v_mfma_f32_16x16x32_bf16 v[84:87], a[120:123], v[164:167], v[84:87]
    ds_read_b128 v[156:159], v40 offset:27648
    ds_read_b64_tr_b16 a[224:225], v10 offset:32768
    v_mfma_f32_16x16x32_bf16 v[88:91], a[124:127], v[164:167], v[88:91]
    s_cbranch_vccnz Lr_h3
Lb_h3:
    v_mfma_f32_16x16x32_bf16 v[92:95], a[128:131], v[164:167], v[92:95]
    ds_read_b64_tr_b16 a[226:227], v10 offset:33280
    ds_read_b64_tr_b16 a[228:229], v11 offset:32768
    v_mfma_f32_16x16x32_bf16 v[72:75], a[168:171], v[144:147], v[72:75]
    ds_read_b128 v[160:163], v40 offset:23552
    buffer_load_dwordx4 v8, s[28:31], s65 offen offset:2048 lds
    v_mfma_f32_16x16x32_bf16 v[76:79], a[172:175], v[144:147], v[76:79]
    ds_read_b64_tr_b16 a[230:231], v11 offset:33280
    ds_read_b64_tr_b16 a[232:233], v12 offset:32768
    v_mfma_f32_16x16x32_bf16 v[80:83], a[176:179], v[144:147], v[80:83]
    s_waitcnt lgkmcnt(8)
    ds_read_b64_tr_b16 a[234:235], v12 offset:33280
    ds_read_b64_tr_b16 a[236:237], v13 offset:32768
    v_mfma_f32_16x16x32_bf16 v[84:87], a[168:171], v[148:151], v[84:87]
    ds_read_b128 v[164:167], v40 offset:31744
    ds_read_b64_tr_b16 a[238:239], v13 offset:33280
    v_mfma_f32_16x16x32_bf16 v[88:91], a[172:175], v[148:151], v[88:91]
    s_barrier
    v_mfma_f32_16x16x32_bf16 v[92:95], a[176:179], v[148:151], v[92:95]
    s_waitcnt lgkmcnt(11)
    buffer_load_dwordx4 v9, s[28:31], s65 offen offset:3072 lds
    v_mfma_f32_16x16x32_bf16 v[72:75], a[132:135], v[152:155], v[72:75]
    ds_read_b128 v[144:147], v40 offset:32768
    ds_read2_b32 v[28:29], v22 offset0:0 offset1:64
    v_mfma_f32_16x16x32_bf16 v[76:79], a[136:139], v[152:155], v[76:79]
    s_add_u32 m0, s63, 0x1c000
    s_add_u32 s65, s58, 0x8000
    ds_read2_b32 v[30:31], v22 offset0:16 offset1:80
    v_mfma_f32_16x16x32_bf16 v[80:83], a[140:143], v[152:155], v[80:83]
    s_waitcnt lgkmcnt(13)
    buffer_load_dwordx4 v1, s[40:43], s65 offen offset:0 sc1 lds
    v_mfma_f32_16x16x32_bf16 v[84:87], a[132:135], v[156:159], v[84:87]
    ds_read_b128 v[148:151], v40 offset:40960
    ds_read2_b32 v[32:33], v22 offset0:32 offset1:96
    v_mfma_f32_16x16x32_bf16 v[88:91], a[136:139], v[156:159], v[88:91]
    ds_read2_b32 v[34:35], v22 offset0:48 offset1:112
    ds_read2_b32 v[36:37], v23 offset0:128 offset1:144
    v_mfma_f32_16x16x32_bf16 v[92:95], a[140:143], v[156:159], v[92:95]
    s_waitcnt lgkmcnt(13)
    ds_read2_b32 v[38:39], v23 offset0:160 offset1:176
    v_mfma_f32_16x16x32_bf16 v[72:75], a[180:183], v[160:163], v[72:75]
    ds_read_b128 v[152:155], v40 offset:36864
    buffer_load_dwordx4 v1, s[40:43], s65 offen offset:1024 sc1 lds
    v_mfma_f32_16x16x32_bf16 v[76:79], a[184:187], v[160:163], v[76:79]
    v_mfma_f32_16x16x32_bf16 v[80:83], a[188:191], v[160:163], v[80:83]
    s_waitcnt lgkmcnt(10)
    v_mfma_f32_16x16x32_bf16 v[84:87], a[180:183], v[164:167], v[84:87]
    ds_read_b128 v[156:159], v40 offset:45056
    v_mfma_f32_16x16x32_bf16 v[88:91], a[184:187], v[164:167], v[88:91]
    buffer_load_dwordx4 v1, s[40:43], s65 offen offset:2048 sc1 lds
    v_mfma_f32_16x16x32_bf16 v[92:95], a[188:191], v[164:167], v[92:95]
    s_waitcnt lgkmcnt(9)
    v_mfma_f32_16x16x32_bf16 v[96:99], a[96:99], v[144:147], v[96:99]
    ds_read_b128 v[160:163], v40 offset:33792
    v_mfma_f32_16x16x32_bf16 v[100:103], a[100:103], v[144:147], v[100:103]
    v_mfma_f32_16x16x32_bf16 v[104:107], a[104:107], v[144:147], v[104:107]
    s_waitcnt lgkmcnt(7)
    v_fmac_f32 v72, v56, v28
    v_fmac_f32 v73, v57, v28
    v_fmac_f32 v74, v58, v28
    v_mfma_f32_16x16x32_bf16 v[108:111], a[96:99], v[148:151], v[108:111]
    ds_read_b128 v[164:167], v40 offset:41984
    buffer_load_dwordx4 v1, s[40:43], s65 offen offset:3072 sc1 lds
    v_mfma_f32_16x16x32_bf16 v[112:115], a[100:103], v[148:151], v[112:115]
    v_fmac_f32 v75, v59, v28
    v_fmac_f32 v76, v60, v28
    v_fmac_f32 v77, v61, v28
    v_mfma_f32_16x16x32_bf16 v[116:119], a[104:107], v[148:151], v[116:119]
    s_waitcnt lgkmcnt(3)
    v_fmac_f32 v78, v62, v28
    v_fmac_f32 v79, v63, v28
    v_fmac_f32 v84, v56, v29
    v_mfma_f32_16x16x32_bf16 v[96:99], a[144:147], v[152:155], v[96:99]
    ds_read_b128 v[144:147], v40 offset:37888
    v_fmac_f32 v85, v57, v29
    v_mfma_f32_16x16x32_bf16 v[100:103], a[148:151], v[152:155], v[100:103]
    s_add_u32 m0, s63, 0
    s_add_u32 s65, s48, 0x28000
    buffer_load_dwordx4 v6, s[28:31], s65 offen offset:0 lds
    v_mfma_f32_16x16x32_bf16 v[104:107], a[152:155], v[152:155], v[104:107]
    s_waitcnt lgkmcnt(3)
    v_fmac_f32 v86, v58, v29
    v_fmac_f32 v87, v59, v29
    v_fmac_f32 v88, v60, v29
    v_mfma_f32_16x16x32_bf16 v[108:111], a[144:147], v[156:159], v[108:111]
    ds_read_b128 v[148:151], v40 offset:46080
    v_fmac_f32 v89, v61, v29
    v_fmac_f32 v90, v62, v29
    v_mfma_f32_16x16x32_bf16 v[112:115], a[148:151], v[156:159], v[112:115]
    v_fmac_f32 v91, v63, v29
    v_mul_f32 v72, v72, v76
    v_mul_f32 v73, v73, v77
    v_mfma_f32_16x16x32_bf16 v[116:119], a[152:155], v[156:159], v[116:119]
    s_waitcnt lgkmcnt(3)
    buffer_load_dwordx4 v7, s[28:31], s65 offen offset:1024 lds
    v_mfma_f32_16x16x32_bf16 v[96:99], a[108:111], v[160:163], v[96:99]
    ds_read_b128 v[152:155], v40 offset:34816
    v_mul_f32 v74, v74, v78
    v_mul_f32 v75, v75, v79
    v_mfma_f32_16x16x32_bf16 v[100:103], a[112:115], v[160:163], v[100:103]
    v_mul_f32 v84, v84, v88
    v_mul_f32 v85, v85, v89
    v_mul_f32 v86, v86, v90
    v_mfma_f32_16x16x32_bf16 v[104:107], a[116:119], v[160:163], v[104:107]
    s_waitcnt lgkmcnt(3)
    v_mul_f32 v87, v87, v91
    v_cvt_pk_bf16_f32 v212, v72, v73
    v_cvt_pk_bf16_f32 v213, v74, v75
    v_mfma_f32_16x16x32_bf16 v[108:111], a[108:111], v[164:167], v[108:111]
    ds_read_b128 v[156:159], v40 offset:43008
    buffer_load_dwordx4 v8, s[28:31], s65 offen offset:2048 lds
    v_mfma_f32_16x16x32_bf16 v[112:115], a[112:115], v[164:167], v[112:115]
    v_cvt_pk_bf16_f32 v214, v84, v85
    v_cvt_pk_bf16_f32 v215, v86, v87
    v_fmac_f32 v80, v64, v28
    v_mfma_f32_16x16x32_bf16 v[116:119], a[116:119], v[164:167], v[116:119]
    s_waitcnt lgkmcnt(3)
    v_fmac_f32 v81, v65, v28
    v_fmac_f32 v82, v66, v28
    v_fmac_f32 v83, v67, v28
    v_mfma_f32_16x16x32_bf16 v[96:99], a[156:159], v[144:147], v[96:99]
    ds_read_b128 v[160:163], v40 offset:38912
    s_waitcnt vmcnt(11)
    v_fmac_f32 v92, v64, v29
    v_mfma_f32_16x16x32_bf16 v[100:103], a[160:163], v[144:147], v[100:103]
    ds_read2st64_b32 v[248:249], v19 offset0:0 offset1:4
    buffer_load_dwordx4 v9, s[28:31], s65 offen offset:3072 lds
    v_mfma_f32_16x16x32_bf16 v[104:107], a[164:167], v[144:147], v[104:107]
    s_waitcnt lgkmcnt(4)
    ds_read2st64_b32 v[250:251], v19 offset0:8 offset1:12
    v_fmac_f32 v93, v65, v29
    v_fmac_f32 v94, v66, v29
    v_mfma_f32_16x16x32_bf16 v[108:111], a[156:159], v[148:151], v[108:111]
    ds_read_b128 v[164:167], v40 offset:47104
    v_fmac_f32 v95, v67, v29
    v_mfma_f32_16x16x32_bf16 v[112:115], a[160:163], v[148:151], v[112:115]
    s_add_u32 m0, s63, 0x4000
    s_add_u32 s65, s48, 0x30000
    v_mfma_f32_16x16x32_bf16 v[116:119], a[164:167], v[148:151], v[116:119]
    s_waitcnt lgkmcnt(5)
    buffer_load_dwordx4 v6, s[28:31], s65 offen offset:0 lds
    v_mfma_f32_16x16x32_bf16 v[96:99], a[120:123], v[152:155], v[96:99]
    ds_read_b128 v[144:147], v40 offset:35840
    s_waitcnt lgkmcnt(3)
    v_bitop3_b32 v26, v248, v249, s96 bitop3:0x7e
    v_mfma_f32_16x16x32_bf16 v[100:103], a[124:127], v[152:155], v[100:103]
    s_waitcnt lgkmcnt(2)
    v_bitop3_b32 v26, v26, v250, s96 bitop3:0xf6
    v_bitop3_b32 v26, v26, v251, s96 bitop3:0xf6
    v_mfma_f32_16x16x32_bf16 v[104:107], a[128:131], v[152:155], v[104:107]
    v_and_b32 v26, s1, v26
    v_cmp_ne_u32 vcc, 0, v26
    v_mfma_f32_16x16x32_bf16 v[108:111], a[120:123], v[156:159], v[108:111]
    ds_read_b128 v[148:151], v40 offset:44032
    v_permlane16_swap_b32 v212, v214
    v_mfma_f32_16x16x32_bf16 v[112:115], a[124:127], v[156:159], v[112:115]
    s_cbranch_vccnz Lr_h4
Lb_h4:
    v_mfma_f32_16x16x32_bf16 v[116:119], a[128:131], v[156:159], v[116:119]
    buffer_load_dwordx4 v7, s[28:31], s65 offen offset:1024 lds
    v_mfma_f32_16x16x32_bf16 v[96:99], a[168:171], v[160:163], v[96:99]
    ds_read_b128 v[152:155], v40 offset:39936
    v_permlane16_swap_b32 v213, v215
    v_mfma_f32_16x16x32_bf16 v[100:103], a[172:175], v[160:163], v[100:103]
    v_add_u32 v212, 0x10002, v212
    v_bfi_b32 v212, s1, v41, v212
    v_mfma_f32_16x16x32_bf16 v[104:107], a[176:179], v[160:163], v[104:107]
    s_waitcnt lgkmcnt(3)
    buffer_load_dwordx4 v8, s[28:31], s65 offen offset:2048 lds
    v_mfma_f32_16x16x32_bf16 v[108:111], a[168:171], v[164:167], v[108:111]
    ds_read_b128 v[156:159], v40 offset:48128
    v_permlane32_swap_b32 v80, v92
    v_mfma_f32_16x16x32_bf16 v[112:115], a[172:175], v[164:167], v[112:115]
    s_barrier
    v_mfma_f32_16x16x32_bf16 v[116:119], a[176:179], v[164:167], v[116:119]
    s_waitcnt lgkmcnt(3)
    v_permlane32_swap_b32 v81, v93
    v_mul_f32 v80, v80, v92
    v_mfma_f32_16x16x32_bf16 v[96:99], a[132:135], v[144:147], v[96:99]
    ds_read_b128 v[160:163], v27 offset:0
    buffer_load_dwordx4 v9, s[28:31], s65 offen offset:3072 lds
    v_mfma_f32_16x16x32_bf16 v[100:103], a[136:139], v[144:147], v[100:103]
    v_permlane32_swap_b32 v82, v94
    v_mul_f32 v81, v81, v93
    v_mfma_f32_16x16x32_bf16 v[104:107], a[140:143], v[144:147], v[104:107]
    s_waitcnt lgkmcnt(3)
    v_permlane32_swap_b32 v83, v95
    v_mul_f32 v82, v82, v94
    v_mfma_f32_16x16x32_bf16 v[108:111], a[132:135], v[148:151], v[108:111]
    ds_read_b128 v[164:167], v27 offset:8192
    s_add_u32 m0, s63, 0x20000
    v_mul_f32 v83, v83, v95
    v_mfma_f32_16x16x32_bf16 v[112:115], a[136:139], v[148:151], v[112:115]
    s_add_u32 s65, s92, 0xc000
    buffer_load_dwordx4 v1, s[40:43], s65 offen offset:0 sc1 lds
    v_mfma_f32_16x16x32_bf16 v[116:119], a[140:143], v[148:151], v[116:119]
    s_waitcnt lgkmcnt(3)
    v_cvt_pk_bf16_f32 v216, v80, v81
    v_cvt_pk_bf16_f32 v218, v80, v81
    v_cvt_pk_bf16_f32 v217, v82, v83
    v_mfma_f32_16x16x32_bf16 v[96:99], a[180:183], v[152:155], v[96:99]
    ds_read_b128 v[144:147], v27 offset:4096
    v_cvt_pk_bf16_f32 v219, v82, v83
    s_add_u32 s99, s98, 0
    v_mfma_f32_16x16x32_bf16 v[100:103], a[184:187], v[152:155], v[100:103]
    buffer_store_dwordx4 v[212:215], v70, s[40:43], s99 offen sc1
    v_mfma_f32_16x16x32_bf16 v[104:107], a[188:191], v[152:155], v[104:107]
    s_waitcnt lgkmcnt(3)
    buffer_load_dwordx4 v1, s[40:43], s65 offen offset:1024 sc1 lds
    v_mfma_f32_16x16x32_bf16 v[108:111], a[180:183], v[156:159], v[108:111]
    ds_read_b128 v[148:151], v27 offset:12288
    v_permlane16_swap_b32 v216, v218
    v_mfma_f32_16x16x32_bf16 v[112:115], a[184:187], v[156:159], v[112:115]
    v_permlane16_swap_b32 v217, v219
    v_add_u32 v216, 0x10002, v216
    v_mfma_f32_16x16x32_bf16 v[116:119], a[188:191], v[156:159], v[116:119]
    s_waitcnt lgkmcnt(3)
    v_bfi_b32 v216, s1, v41, v216
    s_add_u32 s99, s98, 0
    buffer_store_dwordx4 v[216:219], v71, s[40:43], s99 offen offset:512 sc1
    v_mfma_f32_16x16x32_bf16 v[120:123], a[0:3], v[160:163], 0
    ds_read_b128 v[152:155], v27 offset:1024
    v_mfma_f32_16x16x32_bf16 v[124:127], a[4:7], v[160:163], 0
    buffer_load_dwordx4 v1, s[40:43], s65 offen offset:2048 sc1 lds
    v_mfma_f32_16x16x32_bf16 v[128:131], a[8:11], v[160:163], 0
    s_waitcnt lgkmcnt(3)
    v_fmac_f32 v96, v56, v30
    v_fmac_f32 v97, v57, v30
    v_fmac_f32 v98, v58, v30
    v_mfma_f32_16x16x32_bf16 v[132:135], a[0:3], v[164:167], 0
    ds_read_b128 v[156:159], v27 offset:9216
    v_fmac_f32 v99, v59, v30
    v_fmac_f32 v100, v60, v30
    v_mfma_f32_16x16x32_bf16 v[136:139], a[4:7], v[164:167], 0
    v_fmac_f32 v101, v61, v30
    v_fmac_f32 v102, v62, v30
    v_fmac_f32 v103, v63, v30
    v_mfma_f32_16x16x32_bf16 v[140:143], a[8:11], v[164:167], 0
    s_waitcnt lgkmcnt(3)
    buffer_load_dwordx4 v1, s[40:43], s65 offen offset:3072 sc1 lds
    v_mfma_f32_16x16x32_bf16 v[120:123], a[48:51], v[144:147], v[120:123]
    ds_read_b128 v[160:163], v27 offset:5120
    v_fmac_f32 v108, v56, v31
    v_fmac_f32 v109, v57, v31
    v_mfma_f32_16x16x32_bf16 v[124:127], a[52:55], v[144:147], v[124:127]
    v_fmac_f32 v110, v58, v31
    v_fmac_f32 v111, v59, v31
    v_fmac_f32 v112, v60, v31
    v_mfma_f32_16x16x32_bf16 v[128:131], a[56:59], v[144:147], v[128:131]
    s_waitcnt lgkmcnt(3)
    v_fmac_f32 v113, v61, v31
    v_fmac_f32 v114, v62, v31
    v_fmac_f32 v115, v63, v31
    v_mfma_f32_16x16x32_bf16 v[132:135], a[48:51], v[148:151], v[132:135]
    ds_read_b128 v[164:167], v27 offset:13312
    v_mul_f32 v96, v96, v100
    v_mul_f32 v97, v97, v101
    v_mfma_f32_16x16x32_bf16 v[136:139], a[52:55], v[148:151], v[136:139]
    v_mul_f32 v98, v98, v102
    v_mul_f32 v99, v99, v103
    v_mul_f32 v108, v108, v112
    v_mfma_f32_16x16x32_bf16 v[140:143], a[56:59], v[148:151], v[140:143]
    s_waitcnt lgkmcnt(3)
    v_mul_f32 v109, v109, v113
    v_mul_f32 v110, v110, v114
    v_mul_f32 v111, v111, v115
    v_mfma_f32_16x16x32_bf16 v[120:123], a[12:15], v[152:155], v[120:123]
    ds_read_b128 v[144:147], v27 offset:2048
    v_cvt_pk_bf16_f32 v220, v96, v97
    v_mfma_f32_16x16x32_bf16 v[124:127], a[16:19], v[152:155], v[124:127]
    s_add_u32 m0, s63, 0x8000
    s_add_u32 s65, s48, 0x38000
    buffer_load_dwordx4 v6, s[28:31], s65 offen offset:0 lds
    v_mfma_f32_16x16x32_bf16 v[128:131], a[20:23], v[152:155], v[128:131]
    s_waitcnt lgkmcnt(3)
    v_cvt_pk_bf16_f32 v221, v98, v99
    v_cvt_pk_bf16_f32 v222, v108, v109
    v_cvt_pk_bf16_f32 v223, v110, v111
    v_mfma_f32_16x16x32_bf16 v[132:135], a[12:15], v[156:159], v[132:135]
    ds_read_b128 v[148:151], v27 offset:10240
    v_fmac_f32 v104, v64, v30
    v_fmac_f32 v105, v65, v30
    v_mfma_f32_16x16x32_bf16 v[136:139], a[16:19], v[156:159], v[136:139]
    v_fmac_f32 v106, v66, v30
    v_fmac_f32 v107, v67, v30
    v_fmac_f32 v116, v64, v31
    v_mfma_f32_16x16x32_bf16 v[140:143], a[20:23], v[156:159], v[140:143]
    s_waitcnt lgkmcnt(3)
    buffer_load_dwordx4 v7, s[28:31], s65 offen offset:1024 lds
    v_mfma_f32_16x16x32_bf16 v[120:123], a[60:63], v[160:163], v[120:123]
    ds_read_b128 v[152:155], v27 offset:6144
    s_waitcnt vmcnt(16)
    v_fmac_f32 v117, v65, v31
    v_mfma_f32_16x16x32_bf16 v[124:127], a[64:67], v[160:163], v[124:127]
    ds_read2st64_b32 v[248:249], v42 offset0:0 offset1:4
    v_fmac_f32 v118, v66, v31
    v_fmac_f32 v119, v67, v31
    v_mfma_f32_16x16x32_bf16 v[128:131], a[68:71], v[160:163], v[128:131]
    s_waitcnt lgkmcnt(4)
    ds_read2st64_b32 v[250:251], v42 offset0:8 offset1:12
    v_permlane16_swap_b32 v220, v222
    v_mfma_f32_16x16x32_bf16 v[132:135], a[60:63], v[164:167], v[132:135]
    ds_read_b128 v[156:159], v27 offset:14336
    v_permlane16_swap_b32 v221, v223
    v_mfma_f32_16x16x32_bf16 v[136:139], a[64:67], v[164:167], v[136:139]
    buffer_load_dwordx4 v8, s[28:31], s65 offen offset:2048 lds
    v_add_u32 v220, 0x10002, v220
    v_mfma_f32_16x16x32_bf16 v[140:143], a[68:71], v[164:167], v[140:143]
    s_waitcnt lgkmcnt(5)
    v_bfi_b32 v220, s1, v41, v220
    v_permlane32_swap_b32 v104, v116
    v_mfma_f32_16x16x32_bf16 v[120:123], a[24:27], v[144:147], v[120:123]
    ds_read_b128 v[160:163], v27 offset:3072
    s_waitcnt lgkmcnt(3)
    v_bitop3_b32 v26, v248, v249, s96 bitop3:0x7e
    v_mul_f32 v104, v104, v116
    v_mfma_f32_16x16x32_bf16 v[124:127], a[28:31], v[144:147], v[124:127]
    s_waitcnt lgkmcnt(2)
    v_bitop3_b32 v26, v26, v250, s96 bitop3:0xf6
    v_bitop3_b32 v26, v26, v251, s96 bitop3:0xf6
    v_mfma_f32_16x16x32_bf16 v[128:131], a[32:35], v[144:147], v[128:131]
    v_and_b32 v26, s1, v26
    v_cmp_ne_u32 vcc, 0, v26
    buffer_load_dwordx4 v9, s[28:31], s65 offen offset:3072 lds
    v_mfma_f32_16x16x32_bf16 v[132:135], a[24:27], v[148:151], v[132:135]
    ds_read_b128 v[164:167], v27 offset:11264
    v_permlane32_swap_b32 v105, v117
    v_mfma_f32_16x16x32_bf16 v[136:139], a[28:31], v[148:151], v[136:139]
    s_cbranch_vccnz Lr_h5
Lb_h5:
    v_mfma_f32_16x16x32_bf16 v[140:143], a[32:35], v[148:151], v[140:143]
    s_add_u32 m0, s63, 0x18000
    s_add_u32 s65, s48, 0x48000
    v_mul_f32 v105, v105, v117
    v_mfma_f32_16x16x32_bf16 v[120:123], a[72:75], v[152:155], v[120:123]
    ds_read_b128 v[144:147], v27 offset:7168
    buffer_load_dwordx4 v6, s[28:31], s65 offen offset:0 lds
    v_mfma_f32_16x16x32_bf16 v[124:127], a[76:79], v[152:155], v[124:127]
    v_permlane32_swap_b32 v106, v118
    v_mul_f32 v106, v106, v118
    v_mfma_f32_16x16x32_bf16 v[128:131], a[80:83], v[152:155], v[128:131]
    s_waitcnt lgkmcnt(3)
    v_permlane32_swap_b32 v107, v119
    v_mul_f32 v107, v107, v119
    v_mfma_f32_16x16x32_bf16 v[132:135], a[72:75], v[156:159], v[132:135]
    ds_read_b128 v[148:151], v27 offset:15360
    v_cvt_pk_bf16_f32 v224, v104, v105
    v_cvt_pk_bf16_f32 v226, v104, v105
    v_mfma_f32_16x16x32_bf16 v[136:139], a[76:79], v[156:159], v[136:139]
    s_barrier
    v_mfma_f32_16x16x32_bf16 v[140:143], a[80:83], v[156:159], v[140:143]
    s_waitcnt lgkmcnt(3)
    buffer_load_dwordx4 v7, s[28:31], s65 offen offset:1024 lds
    v_mfma_f32_16x16x32_bf16 v[120:123], a[36:39], v[160:163], v[120:123]
    ds_read_b128 v[152:155], v40 offset:0
    v_cvt_pk_bf16_f32 v225, v106, v107
    v_cvt_pk_bf16_f32 v227, v106, v107
    v_mfma_f32_16x16x32_bf16 v[124:127], a[40:43], v[160:163], v[124:127]
    s_add_u32 s99, s98, 0xb400
    buffer_store_dwordx4 v[220:223], v70, s[40:43], s99 offen sc1
    v_mfma_f32_16x16x32_bf16 v[128:131], a[44:47], v[160:163], v[128:131]
    s_waitcnt lgkmcnt(3)
    buffer_load_dwordx4 v8, s[28:31], s65 offen offset:2048 lds
    v_mfma_f32_16x16x32_bf16 v[132:135], a[36:39], v[164:167], v[132:135]
    ds_read_b128 v[156:159], v40 offset:8192
    v_permlane16_swap_b32 v224, v226
    v_mfma_f32_16x16x32_bf16 v[136:139], a[40:43], v[164:167], v[136:139]
    v_permlane16_swap_b32 v225, v227
    v_add_u32 v224, 0x10002, v224
    v_mfma_f32_16x16x32_bf16 v[140:143], a[44:47], v[164:167], v[140:143]
    s_waitcnt lgkmcnt(3)
    v_bfi_b32 v224, s1, v41, v224
    s_add_u32 s99, s98, 0xb400
    buffer_store_dwordx4 v[224:227], v71, s[40:43], s99 offen offset:512 sc1
    v_mfma_f32_16x16x32_bf16 v[120:123], a[84:87], v[144:147], v[120:123]
    ds_read_b128 v[160:163], v40 offset:4096
    v_mfma_f32_16x16x32_bf16 v[124:127], a[88:91], v[144:147], v[124:127]
    buffer_load_dwordx4 v9, s[28:31], s65 offen offset:3072 lds
    v_mfma_f32_16x16x32_bf16 v[128:131], a[92:95], v[144:147], v[128:131]
    s_waitcnt lgkmcnt(3)
    v_mul_f32 v72, v56, v34
    v_mul_f32 v73, v57, v34
    v_mfma_f32_16x16x32_bf16 v[132:135], a[84:87], v[148:151], v[132:135]
    ds_read_b128 v[164:167], v40 offset:12288
    v_mul_f32 v74, v58, v34
    v_mfma_f32_16x16x32_bf16 v[136:139], a[88:91], v[148:151], v[136:139]
    s_add_u32 m0, s63, 0x24000
    s_add_u32 s65, s58, 0xc000
    v_mul_f32 v75, v59, v34
    v_mfma_f32_16x16x32_bf16 v[140:143], a[92:95], v[148:151], v[140:143]
    s_waitcnt lgkmcnt(3)
    buffer_load_dwordx4 v1, s[40:43], s65 offen offset:0 sc1 lds
    v_mfma_f32_16x16x32_bf16 v[120:123], a[96:99], v[152:155], v[120:123]
    ds_read_b128 v[144:147], v40 offset:1024
    v_mul_f32 v76, v60, v34
    v_mfma_f32_16x16x32_bf16 v[124:127], a[100:103], v[152:155], v[124:127]
    v_mul_f32 v77, v61, v34
    v_mul_f32 v78, v62, v34
    v_mfma_f32_16x16x32_bf16 v[128:131], a[104:107], v[152:155], v[128:131]
    s_waitcnt lgkmcnt(3)
    v_xor_b32 v10, 0x10000, v10
    v_mul_f32 v79, v63, v34
    v_mfma_f32_16x16x32_bf16 v[132:135], a[96:99], v[156:159], v[132:135]
    ds_read_b128 v[148:151], v40 offset:9216
    buffer_load_dwordx4 v1, s[40:43], s65 offen offset:1024 sc1 lds
    v_mfma_f32_16x16x32_bf16 v[136:139], a[100:103], v[156:159], v[136:139]
    v_xor_b32 v11, 0x10000, v11
    v_xor_b32 v12, 0x10000, v12
    v_mfma_f32_16x16x32_bf16 v[140:143], a[104:107], v[156:159], v[140:143]
    s_waitcnt lgkmcnt(3)
    v_xor_b32 v13, 0x10000, v13
    v_mul_f32 v80, v64, v34
    v_mfma_f32_16x16x32_bf16 v[120:123], a[144:147], v[160:163], v[120:123]
    ds_read_b128 v[152:155], v40 offset:5120
    v_mul_f32 v81, v65, v34
    v_mfma_f32_16x16x32_bf16 v[124:127], a[148:151], v[160:163], v[124:127]
    buffer_load_dwordx4 v1, s[40:43], s65 offen offset:2048 sc1 lds
    ds_read_b64_tr_b16 a[240:241], v10 offset:0
    v_mfma_f32_16x16x32_bf16 v[128:131], a[152:155], v[160:163], v[128:131]
    s_waitcnt lgkmcnt(4)
    ds_read_b64_tr_b16 a[242:243], v10 offset:512
    v_mul_f32 v82, v66, v34
    v_mfma_f32_16x16x32_bf16 v[132:135], a[144:147], v[164:167], v[132:135]
    ds_read_b128 v[156:159], v40 offset:13312
    ds_read_b64_tr_b16 a[244:245], v11 offset:0
    v_mfma_f32_16x16x32_bf16 v[136:139], a[148:151], v[164:167], v[136:139]
    ds_read_b64_tr_b16 a[246:247], v11 offset:512
    v_mul_f32 v83, v67, v34
    v_mfma_f32_16x16x32_bf16 v[140:143], a[152:155], v[164:167], v[140:143]
    s_waitcnt lgkmcnt(7)
    buffer_load_dwordx4 v1, s[40:43], s65 offen offset:3072 sc1 lds
    v_mfma_f32_16x16x32_bf16 v[120:123], a[108:111], v[144:147], v[120:123]
    ds_read_b128 v[160:163], v40 offset:2048
    ds_read_b64_tr_b16 a[248:249], v12 offset:0
    v_mfma_f32_16x16x32_bf16 v[124:127], a[112:115], v[144:147], v[124:127]
    ds_read_b64_tr_b16 a[250:251], v12 offset:512
    v_mul_f32 v84, v56, v35
    v_mfma_f32_16x16x32_bf16 v[128:131], a[116:119], v[144:147], v[128:131]
    s_waitcnt lgkmcnt(9)
    ds_read_b64_tr_b16 a[252:253], v13 offset:0
    v_mul_f32 v85, v57, v35
    v_mfma_f32_16x16x32_bf16 v[132:135], a[108:111], v[148:151], v[132:135]
    ds_read_b128 v[164:167], v40 offset:10240
    ds_read_b64_tr_b16 a[254:255], v13 offset:512
    v_mfma_f32_16x16x32_bf16 v[136:139], a[112:115], v[148:151], v[136:139]
    s_or_b32 s69, s2, s3
    s_cselect_b32 s69, 0x40000000, 0
    v_or_b32 v68, s69, v17
    v_xor_b32 v69, 0x9e3779b1, v16
    buffer_store_dword v69, v68, s[40:43], 0 offen sc1
    v_mfma_f32_16x16x32_bf16 v[140:143], a[116:119], v[148:151], v[140:143]
    s_waitcnt lgkmcnt(11)
    v_mul_f32 v86, v58, v35
    v_mul_f32 v87, v59, v35
    v_mfma_f32_16x16x32_bf16 v[120:123], a[156:159], v[152:155], v[120:123]
    ds_read_b128 v[144:147], v40 offset:6144
    s_waitcnt vmcnt(15)
    v_mfma_f32_16x16x32_bf16 v[124:127], a[160:163], v[152:155], v[124:127]
    ds_read2st64_b32 v[248:249], v42 offset0:64 offset1:68
    s_waitcnt lgkmcnt(2)
    s_add_u32 m0, s63, 0x10000
    v_mfma_f32_16x16x32_bf16 v[128:131], a[164:167], v[152:155], v[128:131]
    ds_read2st64_b32 v[250:251], v42 offset0:72 offset1:76
    s_add_u32 s65, s48, 0x40000
    buffer_load_dwordx4 v6, s[28:31], s65 offen offset:0 lds
    v_mfma_f32_16x16x32_bf16 v[132:135], a[156:159], v[156:159], v[132:135]
    ds_read_b128 v[148:151], v40 offset:14336
    v_mul_f32 v88, v60, v35
    v_mfma_f32_16x16x32_bf16 v[136:139], a[160:163], v[156:159], v[136:139]
    v_mul_f32 v89, v61, v35
    v_mul_f32 v90, v62, v35
    v_mfma_f32_16x16x32_bf16 v[140:143], a[164:167], v[156:159], v[140:143]
    v_mul_f32 v91, v63, v35
    v_mul_f32 v92, v64, v35
    v_mfma_f32_16x16x32_bf16 v[120:123], a[120:123], v[160:163], v[120:123]
    ds_read_b128 v[152:155], v40 offset:3072
    s_waitcnt lgkmcnt(3)
    v_bitop3_b32 v26, v248, v249, s96 bitop3:0x7e
    buffer_load_dwordx4 v7, s[28:31], s65 offen offset:1024 lds
    v_mfma_f32_16x16x32_bf16 v[124:127], a[124:127], v[160:163], v[124:127]
    s_waitcnt lgkmcnt(2)
    v_bitop3_b32 v26, v26, v250, s96 bitop3:0xf6
    v_bitop3_b32 v26, v26, v251, s96 bitop3:0xf6
    v_mfma_f32_16x16x32_bf16 v[128:131], a[128:131], v[160:163], v[128:131]
    v_and_b32 v26, s1, v26
    v_cmp_ne_u32 vcc, 0, v26
    v_mfma_f32_16x16x32_bf16 v[132:135], a[120:123], v[164:167], v[132:135]
    ds_read_b128 v[156:159], v40 offset:11264
    v_mul_f32 v93, v65, v35
    v_mfma_f32_16x16x32_bf16 v[136:139], a[124:127], v[164:167], v[136:139]
    s_cbranch_vccnz Lr_h6
Lb_h6:
    v_mfma_f32_16x16x32_bf16 v[140:143], a[128:131], v[164:167], v[140:143]
    buffer_load_dwordx4 v8, s[28:31], s65 offen offset:2048 lds
    v_mfma_f32_16x16x32_bf16 v[120:123], a[168:171], v[144:147], v[120:123]
    ds_read_b128 v[160:163], v40 offset:7168
    v_mul_f32 v94, v66, v35
    v_mfma_f32_16x16x32_bf16 v[124:127], a[172:175], v[144:147], v[124:127]
    v_mul_f32 v95, v67, v35
    v_mfma_f32_16x16x32_bf16 v[128:131], a[176:179], v[144:147], v[128:131]
    s_waitcnt lgkmcnt(3)
    buffer_load_dwordx4 v9, s[28:31], s65 offen offset:3072 lds
    v_mfma_f32_16x16x32_bf16 v[132:135], a[168:171], v[148:151], v[132:135]
    ds_read_b128 v[164:167], v40 offset:15360
    v_mfma_f32_16x16x32_bf16 v[136:139], a[172:175], v[148:151], v[136:139]
    s_barrier
    v_mfma_f32_16x16x32_bf16 v[140:143], a[176:179], v[148:151], v[140:143]
    s_waitcnt lgkmcnt(3)
    v_mfma_f32_16x16x32_bf16 v[120:123], a[132:135], v[152:155], v[120:123]
    ds_read_b128 v[144:147], v40 offset:16384
    s_add_u32 m0, s63, 0xc000
    v_mfma_f32_16x16x32_bf16 v[124:127], a[136:139], v[152:155], v[124:127]
    s_add_u32 s65, s48, 0x50000
    buffer_load_dwordx4 v6, s[28:31], s65 offen offset:0 lds
    v_mfma_f32_16x16x32_bf16 v[128:131], a[140:143], v[152:155], v[128:131]
    s_waitcnt lgkmcnt(3)
    v_mfma_f32_16x16x32_bf16 v[132:135], a[132:135], v[156:159], v[132:135]
    ds_read_b128 v[148:151], v40 offset:24576
    v_mfma_f32_16x16x32_bf16 v[136:139], a[136:139], v[156:159], v[136:139]
    v_mfma_f32_16x16x32_bf16 v[140:143], a[140:143], v[156:159], v[140:143]
    s_waitcnt lgkmcnt(3)
    buffer_load_dwordx4 v7, s[28:31], s65 offen offset:1024 lds
    v_mfma_f32_16x16x32_bf16 v[120:123], a[180:183], v[160:163], v[120:123]
    ds_read_b128 v[152:155], v40 offset:20480
    v_mfma_f32_16x16x32_bf16 v[124:127], a[184:187], v[160:163], v[124:127]
    v_mfma_f32_16x16x32_bf16 v[128:131], a[188:191], v[160:163], v[128:131]
    s_waitcnt lgkmcnt(3)
    v_mfma_f32_16x16x32_bf16 v[132:135], a[180:183], v[164:167], v[132:135]
    ds_read_b128 v[156:159], v40 offset:28672
    buffer_load_dwordx4 v8, s[28:31], s65 offen offset:2048 lds
    v_mfma_f32_16x16x32_bf16 v[136:139], a[184:187], v[164:167], v[136:139]
    v_mfma_f32_16x16x32_bf16 v[140:143], a[188:191], v[164:167], v[140:143]
    s_waitcnt lgkmcnt(3)
    v_mfma_f32_16x16x32_bf16 v[72:75], a[0:3], v[144:147], v[72:75]
    ds_read_b128 v[160:163], v40 offset:17408
    v_mfma_f32_16x16x32_bf16 v[76:79], a[4:7], v[144:147], v[76:79]
    buffer_load_dwordx4 v9, s[28:31], s65 offen offset:3072 lds
    v_mfma_f32_16x16x32_bf16 v[80:83], a[8:11], v[144:147], v[80:83]
    s_waitcnt lgkmcnt(3)
    v_fmac_f32 v120, v56, v32
    v_fmac_f32 v121, v57, v32
    v_fmac_f32 v122, v58, v32
    v_fmac_f32 v123, v59, v32
    v_mfma_f32_16x16x32_bf16 v[84:87], a[0:3], v[148:151], v[84:87]
    ds_read_b128 v[164:167], v40 offset:25600
    v_fmac_f32 v124, v60, v32
    v_fmac_f32 v125, v61, v32
    v_fmac_f32 v126, v62, v32
    v_mfma_f32_16x16x32_bf16 v[88:91], a[4:7], v[148:151], v[88:91]
    s_add_u32 s53, s93, 0
    v_fmac_f32 v127, v63, v32
    v_fmac_f32 v132, v56, v33
    v_fmac_f32 v133, v57, v33
    v_fmac_f32 v134, v58, v33
    v_mfma_f32_16x16x32_bf16 v[92:95], a[8:11], v[148:151], v[92:95]
    s_waitcnt lgkmcnt(3)
    buffer_load_dwordx4 v[168:171], v1, s[40:43], s53 offen offset:0 sc1
    v_fmac_f32 v135, v59, v33
    v_mfma_f32_16x16x32_bf16 v[72:75], a[48:51], v[152:155], v[72:75]
    ds_read_b128 v[144:147], v40 offset:21504
    v_fmac_f32 v136, v60, v33
    v_fmac_f32 v137, v61, v33
    v_fmac_f32 v138, v62, v33
    v_mfma_f32_16x16x32_bf16 v[76:79], a[52:55], v[152:155], v[76:79]
    v_fmac_f32 v139, v63, v33
    v_mul_f32 v120, v120, v124
    v_mul_f32 v121, v121, v125
    v_mul_f32 v122, v122, v126
    v_mfma_f32_16x16x32_bf16 v[80:83], a[56:59], v[152:155], v[80:83]
    s_waitcnt lgkmcnt(3)
    v_mul_f32 v123, v123, v127
    v_mul_f32 v132, v132, v136
    v_mul_f32 v133, v133, v137
    v_mul_f32 v134, v134, v138
    v_mfma_f32_16x16x32_bf16 v[84:87], a[48:51], v[156:159], v[84:87]
    ds_read_b128 v[148:151], v40 offset:29696
    v_mul_f32 v135, v135, v139
    v_cvt_pk_bf16_f32 v212, v120, v121
    v_cvt_pk_bf16_f32 v213, v122, v123
    v_mfma_f32_16x16x32_bf16 v[88:91], a[52:55], v[156:159], v[88:91]
    buffer_load_dwordx4 v[172:175], v1, s[40:43], s53 offen offset:1024 sc1
    v_cvt_pk_bf16_f32 v214, v132, v133
    v_cvt_pk_bf16_f32 v215, v134, v135
    v_mfma_f32_16x16x32_bf16 v[92:95], a[56:59], v[156:159], v[92:95]
    s_waitcnt lgkmcnt(3)
    v_fmac_f32 v128, v64, v32
    v_fmac_f32 v129, v65, v32
    v_fmac_f32 v130, v66, v32
    v_fmac_f32 v131, v67, v32
    v_mfma_f32_16x16x32_bf16 v[72:75], a[12:15], v[160:163], v[72:75]
    ds_read_b128 v[152:155], v40 offset:18432
    v_fmac_f32 v140, v64, v33
    v_fmac_f32 v141, v65, v33
    v_fmac_f32 v142, v66, v33
    v_mfma_f32_16x16x32_bf16 v[76:79], a[16:19], v[160:163], v[76:79]
    v_fmac_f32 v143, v67, v33
    v_permlane16_swap_b32 v212, v214
    v_add_u32 v212, 0x10002, v212
    v_mfma_f32_16x16x32_bf16 v[80:83], a[20:23], v[160:163], v[80:83]
    s_waitcnt lgkmcnt(3)
    buffer_load_dwordx4 v[176:179], v1, s[40:43], s53 offen offset:2048 sc1
    v_mfma_f32_16x16x32_bf16 v[84:87], a[12:15], v[164:167], v[84:87]
    ds_read_b128 v[156:159], v40 offset:26624
    v_permlane16_swap_b32 v213, v215
    v_bfi_b32 v212, s1, v41, v212
    v_mfma_f32_16x16x32_bf16 v[88:91], a[16:19], v[164:167], v[88:91]
    v_permlane32_swap_b32 v128, v140
    v_permlane32_swap_b32 v129, v141
    v_mfma_f32_16x16x32_bf16 v[92:95], a[20:23], v[164:167], v[92:95]
    s_waitcnt lgkmcnt(3)
    v_permlane32_swap_b32 v130, v142
    v_permlane32_swap_b32 v131, v143
    v_mfma_f32_16x16x32_bf16 v[72:75], a[60:63], v[144:147], v[72:75]
    ds_read_b128 v[160:163], v40 offset:22528
    s_waitcnt vmcnt(12)
    buffer_load_dwordx4 v[180:183], v1, s[40:43], s53 offen offset:3072 sc1
    v_mfma_f32_16x16x32_bf16 v[76:79], a[64:67], v[144:147], v[76:79]
    ds_read2st64_b32 v[248:249], v42 offset0:128 offset1:132
    v_mul_f32 v128, v128, v140
    v_mul_f32 v129, v129, v141
    v_mul_f32 v130, v130, v142
    v_mfma_f32_16x16x32_bf16 v[80:83], a[68:71], v[144:147], v[80:83]
    s_waitcnt lgkmcnt(4)
    ds_read2st64_b32 v[250:251], v42 offset0:136 offset1:140
    v_mul_f32 v131, v131, v143
    v_cvt_pk_bf16_f32 v216, v128, v129
    v_cvt_pk_bf16_f32 v218, v128, v129
    v_mfma_f32_16x16x32_bf16 v[84:87], a[60:63], v[148:151], v[84:87]
    ds_read_b128 v[164:167], v40 offset:30720
    s_add_u32 s53, s93, 0x1000
    v_cvt_pk_bf16_f32 v217, v130, v131
    v_cvt_pk_bf16_f32 v219, v130, v131
    v_mfma_f32_16x16x32_bf16 v[88:91], a[64:67], v[148:151], v[88:91]
    buffer_load_dwordx4 v[184:187], v1, s[40:43], s53 offen offset:0 sc1
    s_add_u32 s99, s98, 0x16800
    v_mfma_f32_16x16x32_bf16 v[92:95], a[68:71], v[148:151], v[92:95]
    s_waitcnt lgkmcnt(5)
    buffer_store_dwordx4 v[212:215], v70, s[40:43], s99 offen sc1
    v_mfma_f32_16x16x32_bf16 v[72:75], a[24:27], v[152:155], v[72:75]
    ds_read_b128 v[144:147], v40 offset:19456
    s_waitcnt lgkmcnt(3)
    v_bitop3_b32 v26, v248, v249, s96 bitop3:0x7e
    v_permlane16_swap_b32 v216, v218
    v_mfma_f32_16x16x32_bf16 v[76:79], a[28:31], v[152:155], v[76:79]
    s_waitcnt lgkmcnt(2)
    v_bitop3_b32 v26, v26, v250, s96 bitop3:0xf6
    v_bitop3_b32 v26, v26, v251, s96 bitop3:0xf6
    v_permlane16_swap_b32 v217, v219
    v_mfma_f32_16x16x32_bf16 v[80:83], a[32:35], v[152:155], v[80:83]
    v_and_b32 v26, s1, v26
    v_cmp_ne_u32 vcc, 0, v26
    buffer_load_dwordx4 v[188:191], v1, s[40:43], s53 offen offset:1024 sc1
    v_mfma_f32_16x16x32_bf16 v[84:87], a[24:27], v[156:159], v[84:87]
    ds_read_b128 v[148:151], v40 offset:27648
    v_add_u32 v216, 0x10002, v216
    v_bfi_b32 v216, s1, v41, v216
    s_add_u32 s99, s98, 0x16800
    v_mfma_f32_16x16x32_bf16 v[88:91], a[28:31], v[156:159], v[88:91]
    s_cbranch_vccnz Lr_h7
Lb_h7:
    v_mfma_f32_16x16x32_bf16 v[92:95], a[32:35], v[156:159], v[92:95]
    buffer_store_dwordx4 v[216:219], v71, s[40:43], s99 offen offset:512 sc1
    v_mfma_f32_16x16x32_bf16 v[72:75], a[72:75], v[160:163], v[72:75]
    ds_read_b128 v[152:155], v40 offset:23552
    v_mfma_f32_16x16x32_bf16 v[76:79], a[76:79], v[160:163], v[76:79]
    buffer_load_dwordx4 v[192:195], v1, s[40:43], s53 offen offset:2048 sc1
    v_mfma_f32_16x16x32_bf16 v[80:83], a[80:83], v[160:163], v[80:83]
    s_waitcnt lgkmcnt(3)
    v_mfma_f32_16x16x32_bf16 v[84:87], a[72:75], v[164:167], v[84:87]
    ds_read_b128 v[156:159], v40 offset:31744
    v_mfma_f32_16x16x32_bf16 v[88:91], a[76:79], v[164:167], v[88:91]
    s_barrier
    v_mfma_f32_16x16x32_bf16 v[92:95], a[80:83], v[164:167], v[92:95]
    s_waitcnt lgkmcnt(3)
    buffer_load_dwordx4 v[196:199], v1, s[40:43], s53 offen offset:3072 sc1
    v_mfma_f32_16x16x32_bf16 v[72:75], a[36:39], v[144:147], v[72:75]
    ds_read_b128 v[160:163], v40 offset:32768
    ds_read_b64_tr_b16 a[0:1], v10 offset:16384
    v_mfma_f32_16x16x32_bf16 v[76:79], a[40:43], v[144:147], v[76:79]
    ds_read_b64_tr_b16 a[2:3], v10 offset:16896
    v_mfma_f32_16x16x32_bf16 v[80:83], a[44:47], v[144:147], v[80:83]
    s_waitcnt lgkmcnt(5)
    s_add_u32 s53, s93, 0x2000
    ds_read_b64_tr_b16 a[4:5], v11 offset:16384
    v_mfma_f32_16x16x32_bf16 v[84:87], a[36:39], v[148:151], v[84:87]
    ds_read_b128 v[164:167], v40 offset:40960
    buffer_load_dwordx4 v[200:203], v1, s[40:43], s53 offen offset:0 sc1
    v_mfma_f32_16x16x32_bf16 v[88:91], a[40:43], v[148:151], v[88:91]
    ds_read_b64_tr_b16 a[6:7], v11 offset:16896
    ds_read_b64_tr_b16 a[8:9], v12 offset:16384
    v_mfma_f32_16x16x32_bf16 v[92:95], a[44:47], v[148:151], v[92:95]
    s_waitcnt lgkmcnt(8)
    ds_read_b64_tr_b16 a[10:11], v12 offset:16896
    v_mfma_f32_16x16x32_bf16 v[72:75], a[84:87], v[152:155], v[72:75]
    ds_read_b128 v[144:147], v40 offset:36864
    ds_read_b64_tr_b16 a[12:13], v13 offset:16384
    v_mfma_f32_16x16x32_bf16 v[76:79], a[88:91], v[152:155], v[76:79]
    buffer_load_dwordx4 v[204:207], v1, s[40:43], s53 offen offset:1024 sc1
    ds_read_b64_tr_b16 a[14:15], v13 offset:16896
    v_mfma_f32_16x16x32_bf16 v[80:83], a[92:95], v[152:155], v[80:83]
    s_waitcnt lgkmcnt(11)
    v_mfma_f32_16x16x32_bf16 v[84:87], a[84:87], v[156:159], v[84:87]
    ds_read_b128 v[148:151], v40 offset:45056
    v_mfma_f32_16x16x32_bf16 v[88:91], a[88:91], v[156:159], v[88:91]
    v_mfma_f32_16x16x32_bf16 v[92:95], a[92:95], v[156:159], v[92:95]
    s_waitcnt lgkmcnt(11)
    buffer_load_dwordx4 v[208:211], v1, s[40:43], s53 offen offset:2048 sc1
    v_mfma_f32_16x16x32_bf16 v[72:75], a[96:99], v[160:163], v[72:75]
    ds_read_b128 v[152:155], v40 offset:33792
    v_xor_b32 v10, 0x10000, v10
    v_mfma_f32_16x16x32_bf16 v[76:79], a[100:103], v[160:163], v[76:79]
    v_xor_b32 v11, 0x10000, v11
    v_xor_b32 v12, 0x10000, v12
    v_mfma_f32_16x16x32_bf16 v[80:83], a[104:107], v[160:163], v[80:83]
    s_waitcnt lgkmcnt(8)
    v_xor_b32 v13, 0x10000, v13
    v_mfma_f32_16x16x32_bf16 v[84:87], a[96:99], v[164:167], v[84:87]
    ds_read_b128 v[156:159], v40 offset:41984
    s_add_u32 s53, s93, 0xb400
    ds_read_b64_tr_b16 a[48:49], v10 offset:32768
    v_mfma_f32_16x16x32_bf16 v[88:91], a[100:103], v[164:167], v[88:91]
    buffer_load_dwordx4 v[96:99], v1, s[40:43], s53 offen offset:0 sc1
    ds_read_b64_tr_b16 a[50:51], v10 offset:33280
    v_mfma_f32_16x16x32_bf16 v[92:95], a[104:107], v[164:167], v[92:95]
    s_waitcnt lgkmcnt(7)
    ds_read_b64_tr_b16 a[52:53], v11 offset:32768
    ds_read_b64_tr_b16 a[54:55], v11 offset:33280
    v_mfma_f32_16x16x32_bf16 v[72:75], a[144:147], v[144:147], v[72:75]
    ds_read_b128 v[160:163], v40 offset:37888
    ds_read_b64_tr_b16 a[56:57], v12 offset:32768
    v_mfma_f32_16x16x32_bf16 v[76:79], a[148:151], v[144:147], v[76:79]
    ds_read_b64_tr_b16 a[58:59], v12 offset:33280
    v_mfma_f32_16x16x32_bf16 v[80:83], a[152:155], v[144:147], v[80:83]
    s_waitcnt lgkmcnt(9)
    buffer_load_dwordx4 v[100:103], v1, s[40:43], s53 offen offset:1024 sc1
    v_mfma_f32_16x16x32_bf16 v[84:87], a[144:147], v[148:151], v[84:87]
    ds_read_b128 v[164:167], v40 offset:46080
    ds_read_b64_tr_b16 a[60:61], v13 offset:32768
    v_mfma_f32_16x16x32_bf16 v[88:91], a[148:151], v[148:151], v[88:91]
    ds_read_b64_tr_b16 a[62:63], v13 offset:33280
    v_mfma_f32_16x16x32_bf16 v[92:95], a[152:155], v[148:151], v[92:95]
    s_waitcnt lgkmcnt(11)
    ds_read_b64_tr_b16 a[16:17], v10 offset:0
    v_mfma_f32_16x16x32_bf16 v[72:75], a[108:111], v[152:155], v[72:75]
    ds_read_b128 v[144:147], v40 offset:34816
    buffer_load_dwordx4 v[104:107], v1, s[40:43], s53 offen offset:2048 sc1
    v_mfma_f32_16x16x32_bf16 v[76:79], a[112:115], v[152:155], v[76:79]
    ds_read_b64_tr_b16 a[18:19], v10 offset:512
    ds_read_b64_tr_b16 a[20:21], v11 offset:0
    v_mfma_f32_16x16x32_bf16 v[80:83], a[116:119], v[152:155], v[80:83]
    s_waitcnt lgkmcnt(14)
    ds_read_b64_tr_b16 a[22:23], v11 offset:512
    ds_read_b64_tr_b16 a[24:25], v12 offset:0
    v_mfma_f32_16x16x32_bf16 v[84:87], a[108:111], v[156:159], v[84:87]
    ds_read_b128 v[148:151], v40 offset:43008
    ds_read_b64_tr_b16 a[26:27], v12 offset:512
    v_mfma_f32_16x16x32_bf16 v[88:91], a[112:115], v[156:159], v[88:91]
    buffer_load_dwordx4 v[108:111], v1, s[40:43], s53 offen offset:3072 sc1
    ds_read_b64_tr_b16 a[28:29], v13 offset:0
    v_mfma_f32_16x16x32_bf16 v[92:95], a[116:119], v[156:159], v[92:95]
    s_waitcnt lgkmcnt(14)
    ds_read_b64_tr_b16 a[30:31], v13 offset:512
    v_mfma_f32_16x16x32_bf16 v[72:75], a[156:159], v[160:163], v[72:75]
    ds_read_b128 v[152:155], v40 offset:38912
    ds_read_b64_tr_b16 a[32:33], v10 offset:16384
    v_mfma_f32_16x16x32_bf16 v[76:79], a[160:163], v[160:163], v[76:79]
    s_add_u32 s53, s93, 0xc400
    ds_read_b64_tr_b16 a[34:35], v10 offset:16896
    v_mfma_f32_16x16x32_bf16 v[80:83], a[164:167], v[160:163], v[80:83]
    s_waitcnt lgkmcnt(15)
    buffer_load_dwordx4 v[112:115], v1, s[40:43], s53 offen offset:0 sc1
    v_mfma_f32_16x16x32_bf16 v[84:87], a[156:159], v[164:167], v[84:87]
    ds_read_b128 v[156:159], v40 offset:47104
    ds_read_b64_tr_b16 a[36:37], v11 offset:16384
    v_mfma_f32_16x16x32_bf16 v[88:91], a[160:163], v[164:167], v[88:91]
    ds_read_b64_tr_b16 a[38:39], v11 offset:16896
    ds_read_b64_tr_b16 a[40:41], v12 offset:16384
    v_mfma_f32_16x16x32_bf16 v[92:95], a[164:167], v[164:167], v[92:95]
    s_waitcnt lgkmcnt(15)
    ds_read_b64_tr_b16 a[42:43], v12 offset:16896
    v_mfma_f32_16x16x32_bf16 v[72:75], a[120:123], v[144:147], v[72:75]
    ds_read_b128 v[160:163], v40 offset:35840
    ds_read_b64_tr_b16 a[44:45], v13 offset:16384
    v_mfma_f32_16x16x32_bf16 v[76:79], a[124:127], v[144:147], v[76:79]
    buffer_load_dwordx4 v[116:119], v1, s[40:43], s53 offen offset:1024 sc1
    ds_read_b64_tr_b16 a[46:47], v13 offset:16896
    v_mfma_f32_16x16x32_bf16 v[80:83], a[128:131], v[144:147], v[80:83]
    s_waitcnt lgkmcnt(14)
    v_xor_b32 v10, 0x10000, v10
    v_mfma_f32_16x16x32_bf16 v[84:87], a[120:123], v[148:151], v[84:87]
    ds_read_b128 v[164:167], v40 offset:44032
    v_xor_b32 v11, 0x10000, v11
    v_mfma_f32_16x16x32_bf16 v[88:91], a[124:127], v[148:151], v[88:91]
    s_add_u32 s53, s93, 0xc400
    v_xor_b32 v12, 0x10000, v12
    v_mfma_f32_16x16x32_bf16 v[92:95], a[128:131], v[148:151], v[92:95]
    s_waitcnt lgkmcnt(11)
    buffer_load_dwordx4 v[120:123], v1, s[40:43], s53 offen offset:2048 sc1
    v_mfma_f32_16x16x32_bf16 v[72:75], a[168:171], v[152:155], v[72:75]
    ds_read_b128 v[144:147], v40 offset:39936
    v_xor_b32 v13, 0x10000, v13
    v_mfma_f32_16x16x32_bf16 v[76:79], a[172:175], v[152:155], v[76:79]
    ds_read_b64_tr_b16 a[80:81], v10 offset:32768
    ds_read_b64_tr_b16 a[82:83], v10 offset:33280
    v_mfma_f32_16x16x32_bf16 v[80:83], a[176:179], v[152:155], v[80:83]
    s_waitcnt lgkmcnt(11)
    ds_read_b64_tr_b16 a[84:85], v11 offset:32768
    ds_read_b64_tr_b16 a[86:87], v11 offset:33280
    v_mfma_f32_16x16x32_bf16 v[84:87], a[168:171], v[156:159], v[84:87]
    ds_read_b128 v[148:151], v40 offset:48128
    buffer_load_dwordx4 v[124:127], v1, s[40:43], s53 offen offset:3072 sc1
    v_mfma_f32_16x16x32_bf16 v[88:91], a[172:175], v[156:159], v[88:91]
    ds_read_b64_tr_b16 a[88:89], v12 offset:32768
    ds_read_b64_tr_b16 a[90:91], v12 offset:33280
    v_mfma_f32_16x16x32_bf16 v[92:95], a[176:179], v[156:159], v[92:95]
    s_waitcnt lgkmcnt(11)
    ds_read_b64_tr_b16 a[92:93], v13 offset:32768
    v_mfma_f32_16x16x32_bf16 v[72:75], a[132:135], v[160:163], v[72:75]
    s_add_u32 s53, s93, 0xd400
    ds_read_b64_tr_b16 a[94:95], v13 offset:33280
    v_mfma_f32_16x16x32_bf16 v[76:79], a[136:139], v[160:163], v[76:79]
    buffer_load_dwordx4 v[128:131], v1, s[40:43], s53 offen offset:0 sc1
    s_waitcnt vmcnt(26)
    v_mfma_f32_16x16x32_bf16 v[80:83], a[140:143], v[160:163], v[80:83]
    s_waitcnt lgkmcnt(10)
    ds_read_b64_tr_b16 a[64:65], v10 offset:0
    ds_read_b64_tr_b16 a[66:67], v10 offset:512
    v_mfma_f32_16x16x32_bf16 v[84:87], a[132:135], v[164:167], v[84:87]
    ds_read_b64_tr_b16 a[68:69], v11 offset:0
    s_waitcnt vmcnt(21)
    v_xor_b32 v168, v41, v168
    s_waitcnt vmcnt(20)
    v_xor_b32 v172, v41, v172
    v_mfma_f32_16x16x32_bf16 v[88:91], a[136:139], v[164:167], v[88:91]
    ds_read_b64_tr_b16 a[70:71], v11 offset:512
    s_waitcnt vmcnt(19)
    v_xor_b32 v176, v41, v176
    s_waitcnt vmcnt(18)
    v_xor_b32 v180, v41, v180
    v_mfma_f32_16x16x32_bf16 v[92:95], a[140:143], v[164:167], v[92:95]
    s_waitcnt lgkmcnt(13)
    buffer_load_dwordx4 v[132:135], v1, s[40:43], s53 offen offset:1024 sc1
    v_mfma_f32_16x16x32_bf16 v[72:75], a[180:183], v[144:147], v[72:75]
    ds_read_b64_tr_b16 a[72:73], v12 offset:0
    ds_read_b64_tr_b16 a[74:75], v12 offset:512
    v_mfma_f32_16x16x32_bf16 v[76:79], a[184:187], v[144:147], v[76:79]
    ds_read_b64_tr_b16 a[76:77], v13 offset:0
    s_waitcnt vmcnt(18)
    v_xor_b32 v184, v41, v184
    v_or3_b32 v25, v168, v172, v176
    v_mfma_f32_16x16x32_bf16 v[80:83], a[188:191], v[144:147], v[80:83]
    s_waitcnt lgkmcnt(11)
    ds_read_b64_tr_b16 a[78:79], v13 offset:512
    v_or3_b32 v25, v25, v180, v184
    v_and_b32 v25, s1, v25
    v_mfma_f32_16x16x32_bf16 v[84:87], a[180:183], v[148:151], v[84:87]
    v_cmp_ne_u32 vcc, 0, v25
    v_mfma_f32_16x16x32_bf16 v[88:91], a[184:187], v[148:151], v[88:91]
    buffer_load_dwordx4 v[136:139], v1, s[40:43], s53 offen offset:2048 sc1
    v_mfma_f32_16x16x32_bf16 v[92:95], a[188:191], v[148:151], v[92:95]
    s_cbranch_vccnz Lr_g0_0
Lb_g0_0:
    v_mfma_f32_16x16x32_bf16 v[232:235], a[192:195], v[168:171], 0
    v_xor_b32 v10, 0x10000, v10
    v_mfma_f32_16x16x32_bf16 a[112:115], a[196:199], v[168:171], 0
    v_xor_b32 v11, 0x10000, v11
    v_xor_b32 v12, 0x10000, v12
    v_mul_f32 v72, v72, v76
    v_mul_f32 v73, v73, v77
    v_mul_f32 v74, v74, v78
    v_mul_f32 v75, v75, v79
    v_mul_f32 v84, v84, v88
    v_mul_f32 v85, v85, v89
    v_mul_f32 v86, v86, v90
    v_mul_f32 v87, v87, v91
    v_cvt_pk_bf16_f32 v212, v72, v73
    v_cvt_pk_bf16_f32 v213, v74, v75
    v_mfma_f32_16x16x32_bf16 a[116:119], a[200:203], v[168:171], 0
    v_xor_b32 v13, 0x10000, v13
    v_cvt_pk_bf16_f32 v214, v84, v85
    v_cvt_pk_bf16_f32 v215, v86, v87
    s_nop 0
    v_permlane16_swap_b32 v212, v214
    v_permlane16_swap_b32 v213, v215
    v_add_u32 v212, 0x10002, v212
    v_bfi_b32 v212, s1, v41, v212
    v_permlane32_swap_b32 v80, v92
    v_mul_f32 v80, v80, v92
    v_mfma_f32_16x16x32_bf16 a[120:123], a[204:207], v[168:171], 0
    ds_read_b64_tr_b16 a[96:97], v10 offset:49152
    v_permlane32_swap_b32 v81, v93
    v_permlane32_swap_b32 v82, v94
    v_permlane32_swap_b32 v83, v95
    v_mul_f32 v81, v81, v93
    v_mul_f32 v82, v82, v94
    v_mul_f32 v83, v83, v95
    v_cvt_pk_bf16_f32 v216, v80, v81
    v_cvt_pk_bf16_f32 v218, v80, v81
    v_mfma_f32_16x16x32_bf16 v[232:235], a[208:211], v[172:175], v[232:235]
    ds_read_b64_tr_b16 a[98:99], v10 offset:49664
    v_cvt_pk_bf16_f32 v217, v82, v83
    v_cvt_pk_bf16_f32 v219, v82, v83
    s_add_u32 s99, s98, 0x21c00
    buffer_store_dwordx4 v[212:215], v70, s[40:43], s99 offen sc1
    v_permlane16_swap_b32 v216, v218
    v_permlane16_swap_b32 v217, v219
    v_add_u32 v216, 0x10002, v216
    v_mfma_f32_16x16x32_bf16 a[112:115], a[212:215], v[172:175], a[112:115]
    ds_read_b64_tr_b16 a[100:101], v11 offset:49152
    v_bfi_b32 v216, s1, v41, v216
    s_add_u32 s99, s98, 0x21c00
    buffer_store_dwordx4 v[216:219], v71, s[40:43], s99 offen offset:512 sc1
    v_mfma_f32_16x16x32_bf16 a[116:119], a[216:219], v[172:175], a[116:119]
    ds_read_b64_tr_b16 a[102:103], v11 offset:49664
    v_mfma_f32_16x16x32_bf16 a[120:123], a[220:223], v[172:175], a[120:123]
    ds_read_b64_tr_b16 a[104:105], v12 offset:49152
    v_mfma_f32_16x16x32_bf16 v[232:235], a[224:227], v[176:179], v[232:235]
    ds_read_b64_tr_b16 a[106:107], v12 offset:49664
    v_mfma_f32_16x16x32_bf16 a[112:115], a[228:231], v[176:179], a[112:115]
    ds_read_b64_tr_b16 a[108:109], v13 offset:49152
    v_mfma_f32_16x16x32_bf16 a[116:119], a[232:235], v[176:179], a[116:119]
    s_waitcnt vmcnt(19)
    v_xor_b32 v188, v41, v188
    s_waitcnt vmcnt(17)
    v_xor_b32 v192, v41, v192
    v_mfma_f32_16x16x32_bf16 a[120:123], a[236:239], v[176:179], a[120:123]
    s_waitcnt vmcnt(16)
    v_xor_b32 v196, v41, v196
    s_waitcnt vmcnt(15)
    v_xor_b32 v200, v41, v200
    v_mfma_f32_16x16x32_bf16 v[232:235], a[240:243], v[180:183], v[232:235]
    s_waitcnt vmcnt(14)
    v_xor_b32 v204, v41, v204
    s_waitcnt vmcnt(13)
    v_xor_b32 v208, v41, v208
    v_mfma_f32_16x16x32_bf16 a[112:115], a[244:247], v[180:183], a[112:115]
    v_or3_b32 v25, v188, v192, v196
    v_or3_b32 v25, v25, v200, v204
    v_mfma_f32_16x16x32_bf16 a[116:119], a[248:251], v[180:183], a[116:119]
    s_add_u32 s53, s93, 0x16800
    v_bitop3_b32 v25, v25, v208, s1 bitop3:0xa8
    v_mfma_f32_16x16x32_bf16 a[120:123], a[252:255], v[180:183], a[120:123]
    buffer_load_dwordx4 v[144:147], v1, s[40:43], s53 offen offset:0 sc1
    v_mfma_f32_16x16x32_bf16 v[232:235], a[0:3], v[184:187], v[232:235]
    ds_read_b64_tr_b16 a[110:111], v13 offset:49664
    v_cmp_ne_u32 vcc, 0, v25
    v_mfma_f32_16x16x32_bf16 a[112:115], a[4:7], v[184:187], a[112:115]
    v_mfma_f32_16x16x32_bf16 a[116:119], a[8:11], v[184:187], a[116:119]
    s_cbranch_vccnz Lr_g0_5
Lb_g0_5:
    v_mfma_f32_16x16x32_bf16 a[120:123], a[12:15], v[184:187], a[120:123]
    v_mfma_f32_16x16x32_bf16 v[232:235], a[16:19], v[188:191], v[232:235]
    buffer_load_dwordx4 v[148:151], v1, s[40:43], s53 offen offset:1024 sc1
    v_mfma_f32_16x16x32_bf16 a[112:115], a[20:23], v[188:191], a[112:115]
    v_mfma_f32_16x16x32_bf16 a[116:119], a[24:27], v[188:191], a[116:119]
    v_mfma_f32_16x16x32_bf16 a[120:123], a[28:31], v[188:191], a[120:123]
    v_mfma_f32_16x16x32_bf16 v[232:235], a[32:35], v[192:195], v[232:235]
    v_mfma_f32_16x16x32_bf16 a[112:115], a[36:39], v[192:195], a[112:115]
    buffer_load_dwordx4 v[152:155], v1, s[40:43], s53 offen offset:2048 sc1
    v_mfma_f32_16x16x32_bf16 a[116:119], a[40:43], v[192:195], a[116:119]
    v_mfma_f32_16x16x32_bf16 a[120:123], a[44:47], v[192:195], a[120:123]
    v_mfma_f32_16x16x32_bf16 v[232:235], a[48:51], v[196:199], v[232:235]
    v_mfma_f32_16x16x32_bf16 a[112:115], a[52:55], v[196:199], a[112:115]
    v_mfma_f32_16x16x32_bf16 a[116:119], a[56:59], v[196:199], a[116:119]
    buffer_load_dwordx4 v[156:159], v1, s[40:43], s53 offen offset:3072 sc1
    v_mfma_f32_16x16x32_bf16 a[120:123], a[60:63], v[196:199], a[120:123]
    s_waitcnt lgkmcnt(14)
    v_mfma_f32_16x16x32_bf16 v[232:235], a[64:67], v[200:203], v[232:235]
    s_waitcnt lgkmcnt(12)
    v_mfma_f32_16x16x32_bf16 a[112:115], a[68:71], v[200:203], a[112:115]
    s_waitcnt lgkmcnt(10)
    v_mfma_f32_16x16x32_bf16 a[116:119], a[72:75], v[200:203], a[116:119]
    s_waitcnt lgkmcnt(8)
    s_add_u32 s53, s93, 0x17800
    s_waitcnt vmcnt(16)
    v_xor_b32 v96, v41, v96
    v_mfma_f32_16x16x32_bf16 a[120:123], a[76:79], v[200:203], a[120:123]
    buffer_load_dwordx4 v[160:163], v1, s[40:43], s53 offen offset:0 sc1
    v_mfma_f32_16x16x32_bf16 v[232:235], a[80:83], v[204:207], v[232:235]
    s_waitcnt vmcnt(16)
    v_xor_b32 v100, v41, v100
    s_waitcnt vmcnt(15)
    v_xor_b32 v104, v41, v104
    v_mfma_f32_16x16x32_bf16 a[112:115], a[84:87], v[204:207], a[112:115]
    s_waitcnt vmcnt(14)
    v_xor_b32 v108, v41, v108
    s_waitcnt vmcnt(13)
    v_xor_b32 v112, v41, v112
    v_mfma_f32_16x16x32_bf16 a[116:119], a[88:91], v[204:207], a[116:119]
    v_or3_b32 v25, v96, v100, v104
    v_or3_b32 v25, v25, v108, v112
    v_mfma_f32_16x16x32_bf16 a[120:123], a[92:95], v[204:207], a[120:123]
    s_waitcnt lgkmcnt(6)
    s_add_u32 s53, s93, 0x17800
    v_and_b32 v25, s1, v25
    v_mfma_f32_16x16x32_bf16 v[232:235], a[96:99], v[208:211], v[232:235]
    s_waitcnt lgkmcnt(4)
    buffer_load_dwordx4 v[72:75], v1, s[40:43], s53 offen offset:1024 sc1
    v_mfma_f32_16x16x32_bf16 a[112:115], a[100:103], v[208:211], a[112:115]
    s_waitcnt lgkmcnt(2)
    v_cmp_ne_u32 vcc, 0, v25
    v_mfma_f32_16x16x32_bf16 a[116:119], a[104:107], v[208:211], a[116:119]
    s_waitcnt lgkmcnt(0)
    v_mfma_f32_16x16x32_bf16 a[120:123], a[108:111], v[208:211], a[120:123]
    s_cbranch_vccnz Lr_g1_0
Lb_g1_0:
    v_mfma_f32_16x16x32_bf16 v[236:239], a[192:195], v[96:99], 0
    s_barrier
    v_mfma_f32_16x16x32_bf16 a[124:127], a[196:199], v[96:99], 0
    buffer_load_dwordx4 v[76:79], v1, s[40:43], s53 offen offset:2048 sc1
    v_mfma_f32_16x16x32_bf16 a[128:131], a[200:203], v[96:99], 0
    ds_write_b128 v2, a[112:115] offset:0
    v_mfma_f32_16x16x32_bf16 a[132:135], a[204:207], v[96:99], 0
    ds_write_b128 v3, a[116:119] offset:1024
    v_mfma_f32_16x16x32_bf16 v[236:239], a[208:211], v[100:103], v[236:239]
    ds_write_b128 v4, a[120:123] offset:2048
    v_mfma_f32_16x16x32_bf16 a[124:127], a[212:215], v[100:103], a[124:127]
    v_mfma_f32_16x16x32_bf16 a[128:131], a[216:219], v[100:103], a[128:131]
    buffer_load_dwordx4 v[80:83], v1, s[40:43], s53 offen offset:3072 sc1
    v_mfma_f32_16x16x32_bf16 a[132:135], a[220:223], v[100:103], a[132:135]
    v_mfma_f32_16x16x32_bf16 v[236:239], a[224:227], v[104:107], v[236:239]
    v_mfma_f32_16x16x32_bf16 a[124:127], a[228:231], v[104:107], a[124:127]
    v_mfma_f32_16x16x32_bf16 a[128:131], a[232:235], v[104:107], a[128:131]
    s_add_u32 s53, s93, 0x18800
    s_waitcnt vmcnt(15)
    v_xor_b32 v116, v41, v116
    s_waitcnt vmcnt(14)
    v_xor_b32 v120, v41, v120
    v_mfma_f32_16x16x32_bf16 a[132:135], a[236:239], v[104:107], a[132:135]
    buffer_load_dwordx4 v[84:87], v1, s[40:43], s53 offen offset:0 sc1
    v_mfma_f32_16x16x32_bf16 v[236:239], a[240:243], v[108:111], v[236:239]
    s_waitcnt vmcnt(14)
    v_xor_b32 v124, v41, v124
    s_waitcnt vmcnt(13)
    v_xor_b32 v128, v41, v128
    v_mfma_f32_16x16x32_bf16 a[124:127], a[244:247], v[108:111], a[124:127]
    s_waitcnt vmcnt(12)
    v_xor_b32 v132, v41, v132
    s_waitcnt vmcnt(11)
    v_xor_b32 v136, v41, v136
    v_mfma_f32_16x16x32_bf16 a[128:131], a[248:251], v[108:111], a[128:131]
    v_or3_b32 v25, v116, v120, v124
    v_or3_b32 v25, v25, v128, v132
    v_mfma_f32_16x16x32_bf16 a[132:135], a[252:255], v[108:111], a[132:135]
    v_bitop3_b32 v25, v25, v136, s1 bitop3:0xa8
    v_cmp_ne_u32 vcc, 0, v25
    v_mfma_f32_16x16x32_bf16 v[236:239], a[0:3], v[112:115], v[236:239]
    buffer_load_dwordx4 v[88:91], v1, s[40:43], s53 offen offset:1024 sc1
    v_mfma_f32_16x16x32_bf16 a[124:127], a[4:7], v[112:115], a[124:127]
    s_cbranch_vccnz Lr_g1_5
Lb_g1_5:
    v_mfma_f32_16x16x32_bf16 a[128:131], a[8:11], v[112:115], a[128:131]
    v_permlane16_swap_b32 v48, v50
    v_mfma_f32_16x16x32_bf16 a[132:135], a[12:15], v[112:115], a[132:135]
    v_permlane16_swap_b32 v49, v51
    v_mfma_f32_16x16x32_bf16 v[236:239], a[16:19], v[116:119], v[236:239]
    v_permlane16_swap_b32 v52, v54
    v_mfma_f32_16x16x32_bf16 a[124:127], a[20:23], v[116:119], a[124:127]
    buffer_load_dwordx4 v[92:95], v1, s[40:43], s53 offen offset:2048 sc1
    v_mfma_f32_16x16x32_bf16 a[128:131], a[24:27], v[116:119], a[128:131]
    v_permlane16_swap_b32 v53, v55
    v_mfma_f32_16x16x32_bf16 a[132:135], a[28:31], v[116:119], a[132:135]
    v_lshlrev_b32 v20, 10, v14
    v_and_b32 v21, 1, v15
    v_mfma_f32_16x16x32_bf16 v[236:239], a[32:35], v[120:123], v[236:239]
    v_lshl_add_u32 v20, v21, 14, v20
    v_lshrrev_b32 v21, 1, v15
    v_mfma_f32_16x16x32_bf16 a[124:127], a[36:39], v[120:123], a[124:127]
    v_lshl_add_u32 v20, v21, 4, v20
    s_lshl_b32 s50, s45, 5
    v_mfma_f32_16x16x32_bf16 a[128:131], a[40:43], v[120:123], a[128:131]
    s_add_u32 s50, s50, s64
    s_add_u32 s51, s50, 0x8000
    v_lshlrev_b32 v248, 16, v48
    v_mfma_f32_16x16x32_bf16 a[132:135], a[44:47], v[120:123], a[132:135]
    v_and_b32 v249, 0xffff0000, v48
    v_lshlrev_b32 v250, 16, v49
    v_mfma_f32_16x16x32_bf16 v[236:239], a[48:51], v[124:127], v[236:239]
    v_and_b32 v251, 0xffff0000, v49
    v_lshlrev_b32 v252, 16, v50
    v_mfma_f32_16x16x32_bf16 a[124:127], a[52:55], v[124:127], a[124:127]
    v_and_b32 v253, 0xffff0000, v50
    v_lshlrev_b32 v254, 16, v51
    v_mfma_f32_16x16x32_bf16 a[128:131], a[56:59], v[124:127], a[128:131]
    v_and_b32 v255, 0xffff0000, v51
    v_mfma_f32_16x16x32_bf16 a[132:135], a[60:63], v[124:127], a[132:135]
    v_mfma_f32_16x16x32_bf16 v[236:239], a[64:67], v[128:131], v[236:239]
    v_mfma_f32_16x16x32_bf16 a[124:127], a[68:71], v[128:131], a[124:127]
    v_mfma_f32_16x16x32_bf16 a[128:131], a[72:75], v[128:131], a[128:131]
    s_add_u32 s53, s93, 0x21c00
    s_waitcnt vmcnt(10)
    v_xor_b32 v144, v41, v144
    s_waitcnt vmcnt(9)
    v_xor_b32 v148, v41, v148
    v_mfma_f32_16x16x32_bf16 a[132:135], a[76:79], v[128:131], a[132:135]
    buffer_load_dwordx4 v[168:171], v1, s[40:43], s53 offen offset:0 sc1
    v_mfma_f32_16x16x32_bf16 v[236:239], a[80:83], v[132:135], v[236:239]
    s_waitcnt vmcnt(9)
    v_xor_b32 v152, v41, v152
    s_waitcnt vmcnt(8)
    v_xor_b32 v156, v41, v156
    v_mfma_f32_16x16x32_bf16 a[124:127], a[84:87], v[132:135], a[124:127]
    s_waitcnt vmcnt(7)
    v_xor_b32 v160, v41, v160
    v_or3_b32 v25, v144, v148, v152
    v_mfma_f32_16x16x32_bf16 a[128:131], a[88:91], v[132:135], a[128:131]
    buffer_load_dwordx4 v[172:175], v1, s[40:43], s53 offen offset:1024 sc1
    v_mfma_f32_16x16x32_bf16 a[132:135], a[92:95], v[132:135], a[132:135]
    v_or3_b32 v25, v25, v156, v160
    v_and_b32 v25, s1, v25
    v_mfma_f32_16x16x32_bf16 v[236:239], a[96:99], v[136:139], v[236:239]
    v_cmp_ne_u32 vcc, 0, v25
    v_mfma_f32_16x16x32_bf16 a[124:127], a[100:103], v[136:139], a[124:127]
    buffer_load_dwordx4 v[176:179], v1, s[40:43], s53 offen offset:2048 sc1
    v_mfma_f32_16x16x32_bf16 a[128:131], a[104:107], v[136:139], a[128:131]
    s_cbranch_vccnz Lr_g2_0
Lb_g2_0:
    v_mfma_f32_16x16x32_bf16 a[132:135], a[108:111], v[136:139], a[132:135]
    v_mfma_f32_16x16x32_bf16 v[240:243], a[192:195], v[144:147], 0
    buffer_load_dwordx4 v[180:183], v1, s[40:43], s53 offen offset:3072 sc1
    v_mfma_f32_16x16x32_bf16 a[136:139], a[196:199], v[144:147], 0
    s_nop 0
    ds_write_b128 v2, a[124:127] offset:3072
    v_mfma_f32_16x16x32_bf16 a[140:143], a[200:203], v[144:147], 0
    s_add_u32 s53, s93, 0x22c00
    v_mfma_f32_16x16x32_bf16 a[144:147], a[204:207], v[144:147], 0
    buffer_load_dwordx4 v[184:187], v1, s[40:43], s53 offen offset:0 sc1
    v_mfma_f32_16x16x32_bf16 v[240:243], a[208:211], v[148:151], v[240:243]
    ds_write_b128 v3, a[128:131] offset:4096
    v_mfma_f32_16x16x32_bf16 a[136:139], a[212:215], v[148:151], a[136:139]
    ds_write_b128 v4, a[132:135] offset:5120
    v_mfma_f32_16x16x32_bf16 a[140:143], a[216:219], v[148:151], a[140:143]
    buffer_load_dwordx4 v[188:191], v1, s[40:43], s53 offen offset:1024 sc1
    v_mfma_f32_16x16x32_bf16 a[144:147], a[220:223], v[148:151], a[144:147]
    v_mfma_f32_16x16x32_bf16 v[240:243], a[224:227], v[152:155], v[240:243]
    v_mfma_f32_16x16x32_bf16 a[136:139], a[228:231], v[152:155], a[136:139]
    buffer_load_dwordx4 v[192:195], v1, s[40:43], s53 offen offset:2048 sc1
    v_mfma_f32_16x16x32_bf16 a[140:143], a[232:235], v[152:155], a[140:143]
    s_waitcnt vmcnt(12)
    v_xor_b32 v72, v41, v72
    s_waitcnt vmcnt(11)
    v_xor_b32 v76, v41, v76
    v_mfma_f32_16x16x32_bf16 a[144:147], a[236:239], v[152:155], a[144:147]
    s_waitcnt vmcnt(10)
    v_xor_b32 v80, v41, v80
    s_waitcnt vmcnt(9)
    v_xor_b32 v84, v41, v84
    v_mfma_f32_16x16x32_bf16 v[240:243], a[240:243], v[156:159], v[240:243]
    buffer_load_dwordx4 v[196:199], v1, s[40:43], s53 offen offset:3072 sc1
    v_mfma_f32_16x16x32_bf16 a[136:139], a[244:247], v[156:159], a[136:139]
    s_waitcnt vmcnt(9)
    v_xor_b32 v88, v41, v88
    s_waitcnt vmcnt(8)
    v_xor_b32 v92, v41, v92
    v_mfma_f32_16x16x32_bf16 a[140:143], a[248:251], v[156:159], a[140:143]
    s_add_u32 s53, s93, 0x23c00
    v_or3_b32 v25, v72, v76, v80
    v_or3_b32 v25, v25, v84, v88
    v_mfma_f32_16x16x32_bf16 a[144:147], a[252:255], v[156:159], a[144:147]
    buffer_load_dwordx4 v[200:203], v1, s[40:43], s53 offen offset:0 sc1
    v_mfma_f32_16x16x32_bf16 v[240:243], a[0:3], v[160:163], v[240:243]
    v_bitop3_b32 v25, v25, v92, s1 bitop3:0xa8
    v_cmp_ne_u32 vcc, 0, v25
    v_mfma_f32_16x16x32_bf16 a[136:139], a[4:7], v[160:163], a[136:139]
    s_waitcnt lgkmcnt(0)
    s_barrier
    v_mfma_f32_16x16x32_bf16 a[140:143], a[8:11], v[160:163], a[140:143]
    buffer_load_dwordx4 v[204:207], v1, s[40:43], s53 offen offset:1024 sc1
    v_mfma_f32_16x16x32_bf16 a[144:147], a[12:15], v[160:163], a[144:147]
    s_cbranch_vccnz Lr_g2_5
Lb_g2_5:
    v_mfma_f32_16x16x32_bf16 v[240:243], a[16:19], v[72:75], v[240:243]
    ds_read_b128 v[96:99], v5 offset:0
    v_mfma_f32_16x16x32_bf16 a[136:139], a[20:23], v[72:75], a[136:139]
    buffer_load_dwordx4 v[208:211], v1, s[40:43], s53 offen offset:2048 sc1
    v_mfma_f32_16x16x32_bf16 a[140:143], a[24:27], v[72:75], a[140:143]
    ds_read_b128 v[100:103], v5 offset:1024
    v_mfma_f32_16x16x32_bf16 a[144:147], a[28:31], v[72:75], a[144:147]
    ds_read_b128 v[104:107], v5 offset:2048
    v_mfma_f32_16x16x32_bf16 v[240:243], a[32:35], v[76:79], v[240:243]
    ds_read_b128 v[108:111], v5 offset:3072
    v_mfma_f32_16x16x32_bf16 a[136:139], a[36:39], v[76:79], a[136:139]
    ds_read_b128 v[112:115], v5 offset:4096
    v_mfma_f32_16x16x32_bf16 a[140:143], a[40:43], v[76:79], a[140:143]
    ds_read_b128 v[116:119], v5 offset:5120
    v_mfma_f32_16x16x32_bf16 a[144:147], a[44:47], v[76:79], a[144:147]
    v_mfma_f32_16x16x32_bf16 v[240:243], a[48:51], v[80:83], v[240:243]
    v_mfma_f32_16x16x32_bf16 a[136:139], a[52:55], v[80:83], a[136:139]
    v_mfma_f32_16x16x32_bf16 a[140:143], a[56:59], v[80:83], a[140:143]
    s_waitcnt lgkmcnt(5)
    v_add_f32 v232, v232, v96
    v_add_f32 v233, v233, v97
    v_add_f32 v234, v234, v98
    v_add_f32 v235, v235, v99
    v_mfma_f32_16x16x32_bf16 a[144:147], a[60:63], v[80:83], a[144:147]
    s_waitcnt lgkmcnt(3)
    v_add_f32 v100, v100, v104
    v_add_f32 v101, v101, v105
    v_add_f32 v102, v102, v106
    v_add_f32 v103, v103, v107
    v_mfma_f32_16x16x32_bf16 v[240:243], a[64:67], v[84:87], v[240:243]
    v_add_f32 v232, v232, v100
    v_add_f32 v233, v233, v101
    v_add_f32 v234, v234, v102
    v_add_f32 v235, v235, v103
    v_mfma_f32_16x16x32_bf16 a[136:139], a[68:71], v[84:87], a[136:139]
    v_fma_f32 v232, v232, v36, v248
    v_fma_f32 v233, v233, v36, v249
    v_fma_f32 v234, v234, v36, v250
    v_fma_f32 v235, v235, v36, v251
    v_mfma_f32_16x16x32_bf16 a[140:143], a[72:75], v[84:87], a[140:143]
    s_waitcnt vmcnt(10)
    v_xor_b32 v168, v41, v168
    s_waitcnt vmcnt(9)
    v_xor_b32 v172, v41, v172
    v_cvt_pk_bf16_f32 v48, v232, v233
    v_cvt_pk_bf16_f32 v49, v234, v235
    v_mfma_f32_16x16x32_bf16 a[144:147], a[76:79], v[84:87], a[144:147]
    s_waitcnt vmcnt(8)
    v_xor_b32 v176, v41, v176
    s_waitcnt vmcnt(7)
    v_xor_b32 v180, v41, v180
    s_waitcnt lgkmcnt(2)
    v_add_f32 v236, v236, v108
    v_add_f32 v237, v237, v109
    v_mfma_f32_16x16x32_bf16 v[240:243], a[80:83], v[88:91], v[240:243]
    s_waitcnt vmcnt(6)
    v_xor_b32 v184, v41, v184
    v_or3_b32 v25, v168, v172, v176
    v_add_f32 v238, v238, v110
    v_add_f32 v239, v239, v111
    v_mfma_f32_16x16x32_bf16 a[136:139], a[84:87], v[88:91], a[136:139]
    v_or3_b32 v25, v25, v180, v184
    v_and_b32 v25, s1, v25
    s_waitcnt lgkmcnt(0)
    v_add_f32 v112, v112, v116
    v_add_f32 v113, v113, v117
    v_mfma_f32_16x16x32_bf16 a[140:143], a[88:91], v[88:91], a[140:143]
    v_cmp_ne_u32 vcc, 0, v25
    v_add_f32 v114, v114, v118
    v_add_f32 v115, v115, v119
    v_add_f32 v236, v236, v112
    v_mfma_f32_16x16x32_bf16 a[144:147], a[92:95], v[88:91], a[144:147]
    s_barrier
    v_mfma_f32_16x16x32_bf16 v[240:243], a[96:99], v[92:95], v[240:243]
    s_cbranch_vccnz Lr_g3_0
Lb_g3_0:
    v_add_f32 v237, v237, v113
    v_mfma_f32_16x16x32_bf16 a[136:139], a[100:103], v[92:95], a[136:139]
    v_add_f32 v238, v238, v114
    v_add_f32 v239, v239, v115
    v_fma_f32 v236, v236, v37, v252
    v_fma_f32 v237, v237, v37, v253
    v_mfma_f32_16x16x32_bf16 a[140:143], a[104:107], v[92:95], a[140:143]
    v_fma_f32 v238, v238, v37, v254
    v_fma_f32 v239, v239, v37, v255
    v_cvt_pk_bf16_f32 v50, v236, v237
    v_cvt_pk_bf16_f32 v51, v238, v239
    v_mfma_f32_16x16x32_bf16 a[144:147], a[108:111], v[92:95], a[144:147]
    v_permlane16_swap_b32 v48, v50
    v_permlane16_swap_b32 v49, v51
    v_mfma_f32_16x16x32_bf16 a[148:151], a[196:199], v[168:171], 0
    buffer_store_dwordx4 v[48:51], v20, s[32:35], s50 offen
    v_lshlrev_b32 v248, 16, v52
    v_and_b32 v249, 0xffff0000, v52
    v_mfma_f32_16x16x32_bf16 a[152:155], a[200:203], v[168:171], 0
    ds_write_b128 v2, a[136:139] offset:0
    v_mfma_f32_16x16x32_bf16 a[156:159], a[204:207], v[168:171], 0
    ds_write_b128 v3, a[140:143] offset:1024
    v_mfma_f32_16x16x32_bf16 a[148:151], a[212:215], v[172:175], a[148:151]
    ds_write_b128 v4, a[144:147] offset:2048
    v_mfma_f32_16x16x32_bf16 a[152:155], a[216:219], v[172:175], a[152:155]
    v_lshlrev_b32 v250, 16, v53
    v_and_b32 v251, 0xffff0000, v53
    v_lshlrev_b32 v252, 16, v54
    v_and_b32 v253, 0xffff0000, v54
    v_mfma_f32_16x16x32_bf16 a[156:159], a[220:223], v[172:175], a[156:159]
    s_waitcnt vmcnt(6)
    v_xor_b32 v188, v41, v188
    s_waitcnt vmcnt(5)
    v_xor_b32 v192, v41, v192
    v_lshlrev_b32 v254, 16, v55
    v_and_b32 v255, 0xffff0000, v55
    v_mfma_f32_16x16x32_bf16 a[148:151], a[228:231], v[176:179], a[148:151]
    s_waitcnt vmcnt(4)
    v_xor_b32 v196, v41, v196
    s_waitcnt vmcnt(3)
    v_xor_b32 v200, v41, v200
    v_mfma_f32_16x16x32_bf16 a[152:155], a[232:235], v[176:179], a[152:155]
    s_waitcnt vmcnt(2)
    v_xor_b32 v204, v41, v204
    s_waitcnt vmcnt(1)
    v_xor_b32 v208, v41, v208
    v_mfma_f32_16x16x32_bf16 a[156:159], a[236:239], v[176:179], a[156:159]
    v_or3_b32 v25, v188, v192, v196
    v_or3_b32 v25, v25, v200, v204
    v_mfma_f32_16x16x32_bf16 a[148:151], a[244:247], v[180:183], a[148:151]
    v_bitop3_b32 v25, v25, v208, s1 bitop3:0xa8
    v_cmp_ne_u32 vcc, 0, v25
    v_mfma_f32_16x16x32_bf16 a[152:155], a[248:251], v[180:183], a[152:155]
    s_waitcnt lgkmcnt(0)
    s_barrier
    v_mfma_f32_16x16x32_bf16 a[156:159], a[252:255], v[180:183], a[156:159]
    s_cbranch_vccnz Lr_g3_5
Lb_g3_5:
    v_mfma_f32_16x16x32_bf16 a[148:151], a[4:7], v[184:187], a[148:151]
    ds_read_b128 v[96:99], v5 offset:0
    v_mfma_f32_16x16x32_bf16 a[152:155], a[8:11], v[184:187], a[152:155]
    ds_read_b128 v[100:103], v5 offset:1024
    v_mfma_f32_16x16x32_bf16 a[156:159], a[12:15], v[184:187], a[156:159]
    ds_read_b128 v[104:107], v5 offset:2048
    v_mfma_f32_16x16x32_bf16 a[148:151], a[20:23], v[188:191], a[148:151]
    v_mfma_f32_16x16x32_bf16 a[152:155], a[24:27], v[188:191], a[152:155]
    v_mfma_f32_16x16x32_bf16 a[156:159], a[28:31], v[188:191], a[156:159]
    v_mfma_f32_16x16x32_bf16 a[148:151], a[36:39], v[192:195], a[148:151]
    v_mfma_f32_16x16x32_bf16 a[152:155], a[40:43], v[192:195], a[152:155]
    v_mfma_f32_16x16x32_bf16 a[156:159], a[44:47], v[192:195], a[156:159]
    s_waitcnt lgkmcnt(2)
    v_add_f32 v240, v240, v96
    v_add_f32 v241, v241, v97
    v_mfma_f32_16x16x32_bf16 a[148:151], a[52:55], v[196:199], a[148:151]
    v_add_f32 v242, v242, v98
    v_add_f32 v243, v243, v99
    v_mfma_f32_16x16x32_bf16 a[152:155], a[56:59], v[196:199], a[152:155]
    s_waitcnt lgkmcnt(0)
    v_add_f32 v100, v100, v104
    v_add_f32 v101, v101, v105
    v_mfma_f32_16x16x32_bf16 a[156:159], a[60:63], v[196:199], a[156:159]
    v_add_f32 v102, v102, v106
    v_add_f32 v103, v103, v107
    v_mfma_f32_16x16x32_bf16 a[148:151], a[68:71], v[200:203], a[148:151]
    v_add_f32 v240, v240, v100
    v_add_f32 v241, v241, v101
    v_mfma_f32_16x16x32_bf16 a[152:155], a[72:75], v[200:203], a[152:155]
    v_add_f32 v242, v242, v102
    v_add_f32 v243, v243, v103
    v_mfma_f32_16x16x32_bf16 a[156:159], a[76:79], v[200:203], a[156:159]
    v_fma_f32 v240, v240, v38, v248
    v_fma_f32 v241, v241, v38, v249
    v_mfma_f32_16x16x32_bf16 a[148:151], a[84:87], v[204:207], a[148:151]
    v_fma_f32 v242, v242, v38, v250
    v_fma_f32 v243, v243, v38, v251
    v_mfma_f32_16x16x32_bf16 a[152:155], a[88:91], v[204:207], a[152:155]
    v_cvt_pk_bf16_f32 v52, v240, v241
    v_cvt_pk_bf16_f32 v53, v242, v243
    v_mfma_f32_16x16x32_bf16 a[156:159], a[92:95], v[204:207], a[156:159]
    v_mfma_f32_16x16x32_bf16 a[148:151], a[100:103], v[208:211], a[148:151]
    v_mfma_f32_16x16x32_bf16 a[152:155], a[104:107], v[208:211], a[152:155]
    v_mfma_f32_16x16x32_bf16 a[156:159], a[108:111], v[208:211], a[156:159]
    v_mfma_f32_16x16x32_bf16 v[244:247], a[192:195], v[168:171], 0
    v_mfma_f32_16x16x32_bf16 v[244:247], a[208:211], v[172:175], v[244:247]
    s_nop 3
    ds_write_b128 v2, a[148:151] offset:3072
    v_mfma_f32_16x16x32_bf16 v[244:247], a[224:227], v[176:179], v[244:247]
    ds_write_b128 v3, a[152:155] offset:4096
    v_mfma_f32_16x16x32_bf16 v[244:247], a[240:243], v[180:183], v[244:247]
    ds_write_b128 v4, a[156:159] offset:5120
    v_mfma_f32_16x16x32_bf16 v[244:247], a[0:3], v[184:187], v[244:247]
    v_mfma_f32_16x16x32_bf16 v[244:247], a[16:19], v[188:191], v[244:247]
    v_mfma_f32_16x16x32_bf16 v[244:247], a[32:35], v[192:195], v[244:247]
    s_waitcnt lgkmcnt(0)
    s_barrier
    ds_read_b128 v[108:111], v5 offset:3072
    ds_read_b128 v[112:115], v5 offset:4096
    ds_read_b128 v[116:119], v5 offset:5120
    v_mfma_f32_16x16x32_bf16 v[244:247], a[48:51], v[196:199], v[244:247]
    v_mfma_f32_16x16x32_bf16 v[244:247], a[64:67], v[200:203], v[244:247]
    v_mfma_f32_16x16x32_bf16 v[244:247], a[80:83], v[204:207], v[244:247]
    v_mfma_f32_16x16x32_bf16 v[244:247], a[96:99], v[208:211], v[244:247]
    s_waitcnt lgkmcnt(1)
    v_pk_add_f32 v[108:109], v[108:109], v[112:113] op_sel:[0,0] op_sel_hi:[1,1]
    v_pk_add_f32 v[110:111], v[110:111], v[114:115] op_sel:[0,0] op_sel_hi:[1,1]
    s_waitcnt lgkmcnt(0)
    v_pk_add_f32 v[108:109], v[108:109], v[116:117] op_sel:[0,0] op_sel_hi:[1,1]
    v_pk_add_f32 v[110:111], v[110:111], v[118:119] op_sel:[0,0] op_sel_hi:[1,1]
    v_pk_fma_f32 v[108:109], v[108:109], v[38:39], v[252:253] op_sel:[0,1,0] op_sel_hi:[1,1,1]
    v_pk_fma_f32 v[110:111], v[110:111], v[38:39], v[254:255] op_sel:[0,1,0] op_sel_hi:[1,1,1]
    v_pk_fma_f32 v[108:109], v[244:245], v[38:39], v[108:109] op_sel:[0,1,0] op_sel_hi:[1,1,1]
    v_pk_fma_f32 v[110:111], v[246:247], v[38:39], v[110:111] op_sel:[0,1,0] op_sel_hi:[1,1,1]
    v_cvt_pk_bf16_f32 v54, v108, v109
    v_cvt_pk_bf16_f32 v55, v110, v111
    s_nop 0
    v_permlane16_swap_b32 v52, v54
    v_permlane16_swap_b32 v53, v55
    buffer_store_dwordx4 v[52:55], v20, s[32:35], s51 offen
    s_endpgm
Lr_red:
    s_mov_b32 s47, 0
Ll_red:
    buffer_load_dwordx4 v[128:131], v37, s[40:43], s53 offen offset:0 sc1
    buffer_load_dwordx4 v[132:135], v37, s[40:43], s53 offen offset:1024 sc1
    buffer_load_dwordx4 v[136:139], v37, s[40:43], s53 offen offset:2048 sc1
    buffer_load_dwordx4 v[140:143], v37, s[40:43], s53 offen offset:3072 sc1
    buffer_load_dwordx4 v[144:147], v38, s[40:43], s53 offen sc1
    s_waitcnt vmcnt(0)
    v_xor_b32 v128, s61, v128
    v_xor_b32 v129, s89, v129
    v_xor_b32 v130, s90, v130
    v_xor_b32 v131, s91, v131
    v_xor_b32 v132, s61, v132
    v_xor_b32 v133, s89, v133
    v_xor_b32 v134, s90, v134
    v_xor_b32 v135, s91, v135
    v_xor_b32 v136, s61, v136
    v_xor_b32 v137, s89, v137
    v_xor_b32 v138, s90, v138
    v_xor_b32 v139, s91, v139
    v_xor_b32 v140, s61, v140
    v_xor_b32 v141, s89, v141
    v_xor_b32 v142, s90, v142
    v_xor_b32 v143, s91, v143
    v_xor_b32 v144, s61, v144
    v_xor_b32 v145, s89, v145
    v_xor_b32 v146, s90, v146
    v_xor_b32 v147, s91, v147
    v_or3_b32 v196, v128, v129, v130
    v_or3_b32 v196, v196, v131, v132
    v_or3_b32 v196, v196, v133, v134
    v_or3_b32 v196, v196, v135, v136
    v_or3_b32 v196, v196, v137, v138
    v_or3_b32 v196, v196, v139, v140
    v_or3_b32 v196, v196, v141, v142
    v_bitop3_b32 v196, v196, v143, v39 bitop3:0xa8
    v_or3_b32 v197, v144, v145, v146
    v_bitop3_b32 v197, v197, v147, v40 bitop3:0xa8
    v_or_b32 v196, v196, v197
    v_cmp_ne_u32 vcc, 0, v196
    s_add_u32 s47, s47, 1
    s_cbranch_vccz Ld_red
    s_and_b32 s46, s47, 15
    s_cbranch_scc1 Ll_red
    buffer_wbl2 sc1
    buffer_inv sc1
    s_waitcnt vmcnt(0)
    s_cmp_lt_u32 s47, 0x2000
    s_cbranch_scc1 Ll_red
Ld_red:
    s_branch Lb_red
Lr_kvf:
    s_mov_b32 s47, 0
Ll_kvf:
    buffer_load_dwordx4 v[152:155], v80, s[40:43], s50 offen offset:2048 sc1
    buffer_load_dwordx4 v[156:159], v80, s[40:43], s50 offen offset:2560 sc1
    buffer_load_dwordx4 v[144:147], v1, s[40:43], s50 offen sc1
    buffer_load_dwordx4 v[148:151], v1, s[40:43], s50 offen offset:1024 sc1
    s_waitcnt vmcnt(0)
    v_xor_b32 v81, s88, v152
    v_bitop3_b32 v81, v81, v158, s88 bitop3:0xf6
    v_bitop3_b32 v81, v81, v144, s88 bitop3:0xf6
    v_bitop3_b32 v81, v81, v150, s88 bitop3:0xf6
    v_cmp_ne_u32 vcc, 0, v81
    s_add_u32 s47, s47, 1
    s_cbranch_vccz Ld_kvf
    s_and_b32 s46, s47, 15
    s_cbranch_scc1 Ll_kvf
    buffer_wbl2 sc1
    buffer_inv sc1
    s_waitcnt vmcnt(0)
    s_cmp_lt_u32 s47, 0x2000
    s_cbranch_scc1 Ll_kvf
Ld_kvf:
    s_branch Lb_kvf
Lr_kx:
    s_mov_b32 s47, 0
Ll_kx:
    buffer_load_dword v209, v208, s[40:43], 0 offen sc1
    s_waitcnt vmcnt(0)
    v_cmp_ne_u32 vcc, s88, v209
    s_add_u32 s47, s47, 1
    s_cbranch_vccz Ld_kx
    s_and_b32 s46, s47, 15
    s_cbranch_scc1 Ll_kx
    buffer_wbl2 sc1
    buffer_inv sc1
    s_waitcnt vmcnt(0)
    s_cmp_lt_u32 s47, 0x2000
    s_cbranch_scc1 Ll_kx
Ld_kx:
    s_branch Lb_kx
Lr_o0:
    s_mov_b32 s54, m0
    s_mov_b32 s47, 0
Ll_o0:
    s_add_u32 m0, s63, 0xc000
    s_nop 0
    buffer_load_dwordx4 v2, s[40:43], s81 offen offset:0 sc1 lds
    buffer_load_dwordx4 v2, s[40:43], s82 offen offset:1024 sc1 lds
    buffer_load_dwordx4 v2, s[40:43], s83 offen offset:2048 sc1 lds
    buffer_load_dwordx4 v2, s[40:43], s84 offen offset:3072 sc1 lds
    s_add_u32 m0, s63, 0x1c000
    s_nop 0
    buffer_load_dwordx4 v3, s[40:43], s81 offen offset:0 sc1 lds
    buffer_load_dwordx4 v3, s[40:43], s82 offen offset:1024 sc1 lds
    buffer_load_dwordx4 v3, s[40:43], s83 offen offset:2048 sc1 lds
    buffer_load_dwordx4 v3, s[40:43], s84 offen offset:3072 sc1 lds
    s_add_u32 m0, s63, 0x20000
    s_nop 0
    buffer_load_dwordx4 v4, s[40:43], s81 offen offset:0 sc1 lds
    buffer_load_dwordx4 v4, s[40:43], s82 offen offset:1024 sc1 lds
    buffer_load_dwordx4 v4, s[40:43], s83 offen offset:2048 sc1 lds
    buffer_load_dwordx4 v4, s[40:43], s84 offen offset:3072 sc1 lds
    s_add_u32 m0, s63, 0x24000
    s_nop 0
    buffer_load_dwordx4 v5, s[40:43], s81 offen offset:0 sc1 lds
    buffer_load_dwordx4 v5, s[40:43], s82 offen offset:1024 sc1 lds
    buffer_load_dwordx4 v5, s[40:43], s83 offen offset:2048 sc1 lds
    buffer_load_dwordx4 v5, s[40:43], s84 offen offset:3072 sc1 lds
    s_waitcnt vmcnt(0)
    ds_read_b128 v[72:75], v200 offset:0
    ds_read_b128 v[76:79], v200 offset:1024
    ds_read_b128 v[80:83], v200 offset:2048
    ds_read_b128 v[84:87], v200 offset:3072
    s_waitcnt vmcnt(0)
    s_waitcnt lgkmcnt(2)
    v_bitop3_b32 v25, v72, v76, 1 bitop3:0x80
    s_waitcnt lgkmcnt(0)
    v_bitop3_b32 v25, v25, v80, v84 bitop3:0x80
    v_cmp_eq_u32 vcc, 0, v25
    s_add_u32 s47, s47, 1
    s_cbranch_vccz Ld_o0
    s_and_b32 s46, s47, 15
    s_cbranch_scc1 Ll_o0
    buffer_wbl2 sc1
    buffer_inv sc1
    s_waitcnt vmcnt(0)
    s_cmp_lt_u32 s47, 0x2000
    s_cbranch_scc1 Ll_o0
Ld_o0:
    s_mov_b32 m0, s54
    s_branch Lb_o0
Lr_o1:
    s_mov_b32 s54, m0
    s_mov_b32 s47, 0
Ll_o1:
    s_add_u32 m0, s63, 0x1c000
    s_nop 0
    buffer_load_dwordx4 v3, s[40:43], s81 offen offset:0 sc1 lds
    buffer_load_dwordx4 v3, s[40:43], s82 offen offset:1024 sc1 lds
    buffer_load_dwordx4 v3, s[40:43], s83 offen offset:2048 sc1 lds
    buffer_load_dwordx4 v3, s[40:43], s84 offen offset:3072 sc1 lds
    s_waitcnt vmcnt(0)
    ds_read_b128 v[88:91], v201 offset:0
    ds_read_b128 v[92:95], v201 offset:1024
    ds_read_b128 v[96:99], v201 offset:2048
    ds_read_b128 v[100:103], v201 offset:3072
    s_waitcnt vmcnt(0)
    s_waitcnt lgkmcnt(2)
    v_bitop3_b32 v25, v88, v92, 1 bitop3:0x80
    s_waitcnt lgkmcnt(0)
    v_bitop3_b32 v25, v25, v96, v100 bitop3:0x80
    v_cmp_eq_u32 vcc, 0, v25
    s_add_u32 s47, s47, 1
    s_cbranch_vccz Ld_o1
    s_and_b32 s46, s47, 15
    s_cbranch_scc1 Ll_o1
    buffer_wbl2 sc1
    buffer_inv sc1
    s_waitcnt vmcnt(0)
    s_cmp_lt_u32 s47, 0x2000
    s_cbranch_scc1 Ll_o1
Ld_o1:
    s_mov_b32 m0, s54
    s_branch Lb_o1
Lr_o2:
    s_mov_b32 s54, m0
    s_mov_b32 s47, 0
Ll_o2:
    s_add_u32 m0, s63, 0x20000
    s_nop 0
    buffer_load_dwordx4 v4, s[40:43], s81 offen offset:0 sc1 lds
    buffer_load_dwordx4 v4, s[40:43], s82 offen offset:1024 sc1 lds
    buffer_load_dwordx4 v4, s[40:43], s83 offen offset:2048 sc1 lds
    buffer_load_dwordx4 v4, s[40:43], s84 offen offset:3072 sc1 lds
    s_waitcnt vmcnt(0)
    ds_read_b128 v[104:107], v201 offset:16384
    ds_read_b128 v[108:111], v201 offset:17408
    ds_read_b128 v[112:115], v201 offset:18432
    ds_read_b128 v[116:119], v201 offset:19456
    s_waitcnt vmcnt(0)
    s_waitcnt lgkmcnt(2)
    v_bitop3_b32 v25, v104, v108, 1 bitop3:0x80
    s_waitcnt lgkmcnt(0)
    v_bitop3_b32 v25, v25, v112, v116 bitop3:0x80
    v_cmp_eq_u32 vcc, 0, v25
    s_add_u32 s47, s47, 1
    s_cbranch_vccz Ld_o2
    s_and_b32 s46, s47, 15
    s_cbranch_scc1 Ll_o2
    buffer_wbl2 sc1
    buffer_inv sc1
    s_waitcnt vmcnt(0)
    s_cmp_lt_u32 s47, 0x2000
    s_cbranch_scc1 Ll_o2
Ld_o2:
    s_mov_b32 m0, s54
    s_branch Lb_o2
Lr_o3:
    s_mov_b32 s54, m0
    s_mov_b32 s47, 0
Ll_o3:
    s_add_u32 m0, s63, 0x24000
    s_nop 0
    buffer_load_dwordx4 v5, s[40:43], s81 offen offset:0 sc1 lds
    buffer_load_dwordx4 v5, s[40:43], s82 offen offset:1024 sc1 lds
    buffer_load_dwordx4 v5, s[40:43], s83 offen offset:2048 sc1 lds
    buffer_load_dwordx4 v5, s[40:43], s84 offen offset:3072 sc1 lds
    s_waitcnt vmcnt(0)
    ds_read_b128 v[120:123], v201 offset:32768
    ds_read_b128 v[124:127], v201 offset:33792
    ds_read_b128 v[128:131], v201 offset:34816
    ds_read_b128 v[132:135], v201 offset:35840
    s_waitcnt vmcnt(0)
    s_waitcnt lgkmcnt(2)
    v_bitop3_b32 v25, v120, v124, 1 bitop3:0x80
    s_waitcnt lgkmcnt(0)
    v_bitop3_b32 v25, v25, v128, v132 bitop3:0x80
    v_cmp_eq_u32 vcc, 0, v25
    s_add_u32 s47, s47, 1
    s_cbranch_vccz Ld_o3
    s_and_b32 s46, s47, 15
    s_cbranch_scc1 Ll_o3
    buffer_wbl2 sc1
    buffer_inv sc1
    s_waitcnt vmcnt(0)
    s_cmp_lt_u32 s47, 0x2000
    s_cbranch_scc1 Ll_o3
Ld_o3:
    s_mov_b32 m0, s54
    s_branch Lb_o3
Lr_h0:
    s_mov_b32 s54, m0
    s_mov_b32 s55, s65
    s_mov_b32 s47, 0
Ll_h0:
    s_add_u32 m0, s63, 0xc000
    s_add_u32 s65, s92, 0
    buffer_load_dwordx4 v1, s[40:43], s65 offen offset:0 sc1 lds
    buffer_load_dwordx4 v1, s[40:43], s65 offen offset:1024 sc1 lds
    buffer_load_dwordx4 v1, s[40:43], s65 offen offset:2048 sc1 lds
    buffer_load_dwordx4 v1, s[40:43], s65 offen offset:3072 sc1 lds
    s_waitcnt vmcnt(0)
    ds_read2st64_b32 v[248:249], v19 offset0:0 offset1:4
    ds_read2st64_b32 v[250:251], v19 offset0:8 offset1:12
    s_waitcnt vmcnt(0)
    s_waitcnt lgkmcnt(1)
    v_bitop3_b32 v26, v248, v249, s96 bitop3:0x7e
    s_waitcnt lgkmcnt(0)
    v_bitop3_b32 v26, v26, v250, s96 bitop3:0xf6
    v_bitop3_b32 v26, v26, v251, s96 bitop3:0xf6
    v_and_b32 v26, s1, v26
    v_cmp_ne_u32 vcc, 0, v26
    s_add_u32 s47, s47, 1
    s_cbranch_vccz Ld_h0
    s_and_b32 s46, s47, 15
    s_cbranch_scc1 Ll_h0
    buffer_wbl2 sc1
    buffer_inv sc1
    s_waitcnt vmcnt(0)
    s_cmp_lt_u32 s47, 0x2000
    s_cbranch_scc1 Ll_h0
Ld_h0:
    s_mov_b32 m0, s54
    s_mov_b32 s65, s55
    s_branch Lb_h0
Lr_h1:
    s_mov_b32 s54, m0
    s_mov_b32 s55, s65
    s_mov_b32 s47, 0
Ll_h1:
    s_add_u32 m0, s63, 0x1c000
    s_add_u32 s65, s92, 0x4000
    buffer_load_dwordx4 v1, s[40:43], s65 offen offset:0 sc1 lds
    buffer_load_dwordx4 v1, s[40:43], s65 offen offset:1024 sc1 lds
    buffer_load_dwordx4 v1, s[40:43], s65 offen offset:2048 sc1 lds
    buffer_load_dwordx4 v1, s[40:43], s65 offen offset:3072 sc1 lds
    s_waitcnt vmcnt(0)
    ds_read2st64_b32 v[248:249], v42 offset0:0 offset1:4
    ds_read2st64_b32 v[250:251], v42 offset0:8 offset1:12
    s_waitcnt vmcnt(0)
    s_waitcnt lgkmcnt(1)
    v_bitop3_b32 v26, v248, v249, s96 bitop3:0x7e
    s_waitcnt lgkmcnt(0)
    v_bitop3_b32 v26, v26, v250, s96 bitop3:0xf6
    v_bitop3_b32 v26, v26, v251, s96 bitop3:0xf6
    v_and_b32 v26, s1, v26
    v_cmp_ne_u32 vcc, 0, v26
    s_add_u32 s47, s47, 1
    s_cbranch_vccz Ld_h1
    s_and_b32 s46, s47, 15
    s_cbranch_scc1 Ll_h1
    buffer_wbl2 sc1
    buffer_inv sc1
    s_waitcnt vmcnt(0)
    s_cmp_lt_u32 s47, 0x2000
    s_cbranch_scc1 Ll_h1
Ld_h1:
    s_mov_b32 m0, s54
    s_mov_b32 s65, s55
    s_branch Lb_h1
Lr_h2:
    s_mov_b32 s54, m0
    s_mov_b32 s55, s65
    s_mov_b32 s47, 0
Ll_h2:
    s_add_u32 m0, s63, 0x20000
    s_add_u32 s65, s58, 0
    buffer_load_dwordx4 v1, s[40:43], s65 offen offset:0 sc1 lds
    buffer_load_dwordx4 v1, s[40:43], s65 offen offset:1024 sc1 lds
    buffer_load_dwordx4 v1, s[40:43], s65 offen offset:2048 sc1 lds
    buffer_load_dwordx4 v1, s[40:43], s65 offen offset:3072 sc1 lds
    s_waitcnt vmcnt(0)
    ds_read2st64_b32 v[248:249], v42 offset0:64 offset1:68
    ds_read2st64_b32 v[250:251], v42 offset0:72 offset1:76
    s_waitcnt vmcnt(0)
    s_waitcnt lgkmcnt(1)
    v_bitop3_b32 v26, v248, v249, s96 bitop3:0x7e
    s_waitcnt lgkmcnt(0)
    v_bitop3_b32 v26, v26, v250, s96 bitop3:0xf6
    v_bitop3_b32 v26, v26, v251, s96 bitop3:0xf6
    v_and_b32 v26, s1, v26
    v_cmp_ne_u32 vcc, 0, v26
    s_add_u32 s47, s47, 1
    s_cbranch_vccz Ld_h2
    s_and_b32 s46, s47, 15
    s_cbranch_scc1 Ll_h2
    buffer_wbl2 sc1
    buffer_inv sc1
    s_waitcnt vmcnt(0)
    s_cmp_lt_u32 s47, 0x2000
    s_cbranch_scc1 Ll_h2
Ld_h2:
    s_mov_b32 m0, s54
    s_mov_b32 s65, s55
    s_branch Lb_h2
Lr_h3:
    s_mov_b32 s54, m0
    s_mov_b32 s55, s65
    s_mov_b32 s47, 0
Ll_h3:
    s_add_u32 m0, s63, 0x24000
    s_add_u32 s65, s58, 0x4000
    buffer_load_dwordx4 v1, s[40:43], s65 offen offset:0 sc1 lds
    buffer_load_dwordx4 v1, s[40:43], s65 offen offset:1024 sc1 lds
    buffer_load_dwordx4 v1, s[40:43], s65 offen offset:2048 sc1 lds
    buffer_load_dwordx4 v1, s[40:43], s65 offen offset:3072 sc1 lds
    s_waitcnt vmcnt(0)
    ds_read2st64_b32 v[248:249], v42 offset0:128 offset1:132
    ds_read2st64_b32 v[250:251], v42 offset0:136 offset1:140
    s_waitcnt vmcnt(0)
    s_waitcnt lgkmcnt(1)
    v_bitop3_b32 v26, v248, v249, s96 bitop3:0x7e
    s_waitcnt lgkmcnt(0)
    v_bitop3_b32 v26, v26, v250, s96 bitop3:0xf6
    v_bitop3_b32 v26, v26, v251, s96 bitop3:0xf6
    v_and_b32 v26, s1, v26
    v_cmp_ne_u32 vcc, 0, v26
    s_add_u32 s47, s47, 1
    s_cbranch_vccz Ld_h3
    s_and_b32 s46, s47, 15
    s_cbranch_scc1 Ll_h3
    buffer_wbl2 sc1
    buffer_inv sc1
    s_waitcnt vmcnt(0)
    s_cmp_lt_u32 s47, 0x2000
    s_cbranch_scc1 Ll_h3
Ld_h3:
    s_mov_b32 m0, s54
    s_mov_b32 s65, s55
    s_branch Lb_h3
Lr_h4:
    s_mov_b32 s54, m0
    s_mov_b32 s55, s65
    s_mov_b32 s47, 0
Ll_h4:
    s_add_u32 m0, s63, 0xc000
    s_add_u32 s65, s92, 0x8000
    buffer_load_dwordx4 v1, s[40:43], s65 offen offset:0 sc1 lds
    buffer_load_dwordx4 v1, s[40:43], s65 offen offset:1024 sc1 lds
    buffer_load_dwordx4 v1, s[40:43], s65 offen offset:2048 sc1 lds
    buffer_load_dwordx4 v1, s[40:43], s65 offen offset:3072 sc1 lds
    s_waitcnt vmcnt(0)
    ds_read2st64_b32 v[248:249], v19 offset0:0 offset1:4
    ds_read2st64_b32 v[250:251], v19 offset0:8 offset1:12
    s_waitcnt vmcnt(0)
    s_waitcnt lgkmcnt(1)
    v_bitop3_b32 v26, v248, v249, s96 bitop3:0x7e
    s_waitcnt lgkmcnt(0)
    v_bitop3_b32 v26, v26, v250, s96 bitop3:0xf6
    v_bitop3_b32 v26, v26, v251, s96 bitop3:0xf6
    v_and_b32 v26, s1, v26
    v_cmp_ne_u32 vcc, 0, v26
    s_add_u32 s47, s47, 1
    s_cbranch_vccz Ld_h4
    s_and_b32 s46, s47, 15
    s_cbranch_scc1 Ll_h4
    buffer_wbl2 sc1
    buffer_inv sc1
    s_waitcnt vmcnt(0)
    s_cmp_lt_u32 s47, 0x2000
    s_cbranch_scc1 Ll_h4
Ld_h4:
    s_mov_b32 m0, s54
    s_mov_b32 s65, s55
    s_branch Lb_h4
Lr_h5:
    s_mov_b32 s54, m0
    s_mov_b32 s55, s65
    s_mov_b32 s47, 0
Ll_h5:
    s_add_u32 m0, s63, 0x1c000
    s_add_u32 s65, s58, 0x8000
    buffer_load_dwordx4 v1, s[40:43], s65 offen offset:0 sc1 lds
    buffer_load_dwordx4 v1, s[40:43], s65 offen offset:1024 sc1 lds
    buffer_load_dwordx4 v1, s[40:43], s65 offen offset:2048 sc1 lds
    buffer_load_dwordx4 v1, s[40:43], s65 offen offset:3072 sc1 lds
    s_waitcnt vmcnt(0)
    ds_read2st64_b32 v[248:249], v42 offset0:0 offset1:4
    ds_read2st64_b32 v[250:251], v42 offset0:8 offset1:12
    s_waitcnt vmcnt(0)
    s_waitcnt lgkmcnt(1)
    v_bitop3_b32 v26, v248, v249, s96 bitop3:0x7e
    s_waitcnt lgkmcnt(0)
    v_bitop3_b32 v26, v26, v250, s96 bitop3:0xf6
    v_bitop3_b32 v26, v26, v251, s96 bitop3:0xf6
    v_and_b32 v26, s1, v26
    v_cmp_ne_u32 vcc, 0, v26
    s_add_u32 s47, s47, 1
    s_cbranch_vccz Ld_h5
    s_and_b32 s46, s47, 15
    s_cbranch_scc1 Ll_h5
    buffer_wbl2 sc1
    buffer_inv sc1
    s_waitcnt vmcnt(0)
    s_cmp_lt_u32 s47, 0x2000
    s_cbranch_scc1 Ll_h5
Ld_h5:
    s_mov_b32 m0, s54
    s_mov_b32 s65, s55
    s_branch Lb_h5
Lr_h6:
    s_mov_b32 s54, m0
    s_mov_b32 s55, s65
    s_mov_b32 s47, 0
Ll_h6:
    s_add_u32 m0, s63, 0x20000
    s_add_u32 s65, s92, 0xc000
    buffer_load_dwordx4 v1, s[40:43], s65 offen offset:0 sc1 lds
    buffer_load_dwordx4 v1, s[40:43], s65 offen offset:1024 sc1 lds
    buffer_load_dwordx4 v1, s[40:43], s65 offen offset:2048 sc1 lds
    buffer_load_dwordx4 v1, s[40:43], s65 offen offset:3072 sc1 lds
    s_waitcnt vmcnt(0)
    ds_read2st64_b32 v[248:249], v42 offset0:64 offset1:68
    ds_read2st64_b32 v[250:251], v42 offset0:72 offset1:76
    s_waitcnt vmcnt(0)
    s_waitcnt lgkmcnt(1)
    v_bitop3_b32 v26, v248, v249, s96 bitop3:0x7e
    s_waitcnt lgkmcnt(0)
    v_bitop3_b32 v26, v26, v250, s96 bitop3:0xf6
    v_bitop3_b32 v26, v26, v251, s96 bitop3:0xf6
    v_and_b32 v26, s1, v26
    v_cmp_ne_u32 vcc, 0, v26
    s_add_u32 s47, s47, 1
    s_cbranch_vccz Ld_h6
    s_and_b32 s46, s47, 15
    s_cbranch_scc1 Ll_h6
    buffer_wbl2 sc1
    buffer_inv sc1
    s_waitcnt vmcnt(0)
    s_cmp_lt_u32 s47, 0x2000
    s_cbranch_scc1 Ll_h6
Ld_h6:
    s_mov_b32 m0, s54
    s_mov_b32 s65, s55
    s_branch Lb_h6
Lr_h7:
    s_mov_b32 s54, m0
    s_mov_b32 s55, s65
    s_mov_b32 s47, 0
Ll_h7:
    s_add_u32 m0, s63, 0x24000
    s_add_u32 s65, s58, 0xc000
    buffer_load_dwordx4 v1, s[40:43], s65 offen offset:0 sc1 lds
    buffer_load_dwordx4 v1, s[40:43], s65 offen offset:1024 sc1 lds
    buffer_load_dwordx4 v1, s[40:43], s65 offen offset:2048 sc1 lds
    buffer_load_dwordx4 v1, s[40:43], s65 offen offset:3072 sc1 lds
    s_waitcnt vmcnt(0)
    ds_read2st64_b32 v[248:249], v42 offset0:128 offset1:132
    ds_read2st64_b32 v[250:251], v42 offset0:136 offset1:140
    s_waitcnt vmcnt(0)
    s_waitcnt lgkmcnt(1)
    v_bitop3_b32 v26, v248, v249, s96 bitop3:0x7e
    s_waitcnt lgkmcnt(0)
    v_bitop3_b32 v26, v26, v250, s96 bitop3:0xf6
    v_bitop3_b32 v26, v26, v251, s96 bitop3:0xf6
    v_and_b32 v26, s1, v26
    v_cmp_ne_u32 vcc, 0, v26
    s_add_u32 s47, s47, 1
    s_cbranch_vccz Ld_h7
    s_and_b32 s46, s47, 15
    s_cbranch_scc1 Ll_h7
    buffer_wbl2 sc1
    buffer_inv sc1
    s_waitcnt vmcnt(0)
    s_cmp_lt_u32 s47, 0x2000
    s_cbranch_scc1 Ll_h7
Ld_h7:
    s_mov_b32 m0, s54
    s_mov_b32 s65, s55
    s_branch Lb_h7
Lr_st:
    s_mov_b32 s47, 0
Ll_st:
    buffer_load_dword v220, v21, s[40:43], s51 offen offset:0 sc1
    buffer_load_dword v221, v21, s[40:43], s51 offen offset:512 sc1
    buffer_load_dword v222, v21, s[40:43], s51 offen offset:1024 sc1
    buffer_load_dword v223, v21, s[40:43], s51 offen offset:1536 sc1
    buffer_load_dword v224, v21, s[40:43], s51 offen offset:2048 sc1
    buffer_load_dword v225, v21, s[40:43], s51 offen offset:2560 sc1
    buffer_load_dword v226, v21, s[40:43], s51 offen offset:3072 sc1
    buffer_load_dword v227, v21, s[40:43], s51 offen offset:3584 sc1
    s_waitcnt vmcnt(0)
    v_xor_b32 v220, v229, v220
    v_xor_b32 v221, v229, v221
    v_xor_b32 v222, v229, v222
    v_xor_b32 v223, v229, v223
    v_xor_b32 v224, v229, v224
    v_xor_b32 v225, v229, v225
    v_xor_b32 v226, v229, v226
    v_xor_b32 v227, v229, v227
    v_or3_b32 v228, v220, v221, v222
    v_or3_b32 v228, v228, v223, v224
    v_or3_b32 v228, v228, v225, v226
    v_bitop3_b32 v228, v228, v227, 3 bitop3:0xa8
    v_cmp_ne_u32 vcc, 0, v228
    s_add_u32 s47, s47, 1
    s_cbranch_vccz Ld_st
    s_and_b32 s46, s47, 15
    s_cbranch_scc1 Ll_st
    buffer_wbl2 sc1
    buffer_inv sc1
    s_waitcnt vmcnt(0)
    s_cmp_lt_u32 s47, 0x2000
    s_cbranch_scc1 Ll_st
Ld_st:
    s_branch Lb_st
Lr_g0_0:
    s_mov_b32 s54, s53
    s_mov_b32 s47, 0
Ll_g0_0:
    s_add_u32 s53, s93, 0
    buffer_load_dwordx4 v[168:171], v1, s[40:43], s53 offen offset:0 sc1
    buffer_load_dwordx4 v[172:175], v1, s[40:43], s53 offen offset:1024 sc1
    buffer_load_dwordx4 v[176:179], v1, s[40:43], s53 offen offset:2048 sc1
    buffer_load_dwordx4 v[180:183], v1, s[40:43], s53 offen offset:3072 sc1
    s_add_u32 s53, s93, 0x1000
    buffer_load_dwordx4 v[184:187], v1, s[40:43], s53 offen offset:0 sc1
    s_waitcnt vmcnt(0)
    v_xor_b32 v168, v41, v168
    v_xor_b32 v172, v41, v172
    v_xor_b32 v176, v41, v176
    v_xor_b32 v180, v41, v180
    v_xor_b32 v184, v41, v184
    v_or3_b32 v25, v168, v172, v176
    v_or3_b32 v25, v25, v180, v184
    v_and_b32 v25, s1, v25
    v_cmp_ne_u32 vcc, 0, v25
    s_add_u32 s47, s47, 1
    s_cbranch_vccz Ld_g0_0
    s_and_b32 s46, s47, 15
    s_cbranch_scc1 Ll_g0_0
    buffer_wbl2 sc1
    buffer_inv sc1
    s_waitcnt vmcnt(0)
    s_cmp_lt_u32 s47, 0x2000
    s_cbranch_scc1 Ll_g0_0
Ld_g0_0:
    s_mov_b32 s53, s54
    s_branch Lb_g0_0
Lr_g0_5:
    s_mov_b32 s54, s53
    s_mov_b32 s47, 0
Ll_g0_5:
    s_add_u32 s53, s93, 0x1000
    buffer_load_dwordx4 v[188:191], v1, s[40:43], s53 offen offset:1024 sc1
    buffer_load_dwordx4 v[192:195], v1, s[40:43], s53 offen offset:2048 sc1
    buffer_load_dwordx4 v[196:199], v1, s[40:43], s53 offen offset:3072 sc1
    s_add_u32 s53, s93, 0x2000
    buffer_load_dwordx4 v[200:203], v1, s[40:43], s53 offen offset:0 sc1
    buffer_load_dwordx4 v[204:207], v1, s[40:43], s53 offen offset:1024 sc1
    buffer_load_dwordx4 v[208:211], v1, s[40:43], s53 offen offset:2048 sc1
    s_waitcnt vmcnt(0)
    v_xor_b32 v188, v41, v188
    v_xor_b32 v192, v41, v192
    v_xor_b32 v196, v41, v196
    v_xor_b32 v200, v41, v200
    v_xor_b32 v204, v41, v204
    v_xor_b32 v208, v41, v208
    v_or3_b32 v25, v188, v192, v196
    v_or3_b32 v25, v25, v200, v204
    v_bitop3_b32 v25, v25, v208, s1 bitop3:0xa8
    v_cmp_ne_u32 vcc, 0, v25
    s_add_u32 s47, s47, 1
    s_cbranch_vccz Ld_g0_5
    s_and_b32 s46, s47, 15
    s_cbranch_scc1 Ll_g0_5
    buffer_wbl2 sc1
    buffer_inv sc1
    s_waitcnt vmcnt(0)
    s_cmp_lt_u32 s47, 0x2000
    s_cbranch_scc1 Ll_g0_5
Ld_g0_5:
    s_mov_b32 s53, s54
    s_branch Lb_g0_5
Lr_g1_0:
    s_mov_b32 s54, s53
    s_mov_b32 s47, 0
Ll_g1_0:
    s_add_u32 s53, s93, 0xb400
    buffer_load_dwordx4 v[96:99], v1, s[40:43], s53 offen offset:0 sc1
    buffer_load_dwordx4 v[100:103], v1, s[40:43], s53 offen offset:1024 sc1
    buffer_load_dwordx4 v[104:107], v1, s[40:43], s53 offen offset:2048 sc1
    buffer_load_dwordx4 v[108:111], v1, s[40:43], s53 offen offset:3072 sc1
    s_add_u32 s53, s93, 0xc400
    buffer_load_dwordx4 v[112:115], v1, s[40:43], s53 offen offset:0 sc1
    s_waitcnt vmcnt(0)
    v_xor_b32 v96, v41, v96
    v_xor_b32 v100, v41, v100
    v_xor_b32 v104, v41, v104
    v_xor_b32 v108, v41, v108
    v_xor_b32 v112, v41, v112
    v_or3_b32 v25, v96, v100, v104
    v_or3_b32 v25, v25, v108, v112
    v_and_b32 v25, s1, v25
    v_cmp_ne_u32 vcc, 0, v25
    s_add_u32 s47, s47, 1
    s_cbranch_vccz Ld_g1_0
    s_and_b32 s46, s47, 15
    s_cbranch_scc1 Ll_g1_0
    buffer_wbl2 sc1
    buffer_inv sc1
    s_waitcnt vmcnt(0)
    s_cmp_lt_u32 s47, 0x2000
    s_cbranch_scc1 Ll_g1_0
Ld_g1_0:
    s_mov_b32 s53, s54
    s_branch Lb_g1_0
Lr_g1_5:
    s_mov_b32 s54, s53
    s_mov_b32 s47, 0
Ll_g1_5:
    s_add_u32 s53, s93, 0xc400
    buffer_load_dwordx4 v[116:119], v1, s[40:43], s53 offen offset:1024 sc1
    buffer_load_dwordx4 v[120:123], v1, s[40:43], s53 offen offset:2048 sc1
    buffer_load_dwordx4 v[124:127], v1, s[40:43], s53 offen offset:3072 sc1
    s_add_u32 s53, s93, 0xd400
    buffer_load_dwordx4 v[128:131], v1, s[40:43], s53 offen offset:0 sc1
    buffer_load_dwordx4 v[132:135], v1, s[40:43], s53 offen offset:1024 sc1
    buffer_load_dwordx4 v[136:139], v1, s[40:43], s53 offen offset:2048 sc1
    s_waitcnt vmcnt(0)
    v_xor_b32 v116, v41, v116
    v_xor_b32 v120, v41, v120
    v_xor_b32 v124, v41, v124
    v_xor_b32 v128, v41, v128
    v_xor_b32 v132, v41, v132
    v_xor_b32 v136, v41, v136
    v_or3_b32 v25, v116, v120, v124
    v_or3_b32 v25, v25, v128, v132
    v_bitop3_b32 v25, v25, v136, s1 bitop3:0xa8
    v_cmp_ne_u32 vcc, 0, v25
    s_add_u32 s47, s47, 1
    s_cbranch_vccz Ld_g1_5
    s_and_b32 s46, s47, 15
    s_cbranch_scc1 Ll_g1_5
    buffer_wbl2 sc1
    buffer_inv sc1
    s_waitcnt vmcnt(0)
    s_cmp_lt_u32 s47, 0x2000
    s_cbranch_scc1 Ll_g1_5
Ld_g1_5:
    s_mov_b32 s53, s54
    s_branch Lb_g1_5
Lr_g2_0:
    s_mov_b32 s54, s53
    s_mov_b32 s47, 0
Ll_g2_0:
    s_add_u32 s53, s93, 0x16800
    buffer_load_dwordx4 v[144:147], v1, s[40:43], s53 offen offset:0 sc1
    buffer_load_dwordx4 v[148:151], v1, s[40:43], s53 offen offset:1024 sc1
    buffer_load_dwordx4 v[152:155], v1, s[40:43], s53 offen offset:2048 sc1
    buffer_load_dwordx4 v[156:159], v1, s[40:43], s53 offen offset:3072 sc1
    s_add_u32 s53, s93, 0x17800
    buffer_load_dwordx4 v[160:163], v1, s[40:43], s53 offen offset:0 sc1
    s_waitcnt vmcnt(0)
    v_xor_b32 v144, v41, v144
    v_xor_b32 v148, v41, v148
    v_xor_b32 v152, v41, v152
    v_xor_b32 v156, v41, v156
    v_xor_b32 v160, v41, v160
    v_or3_b32 v25, v144, v148, v152
    v_or3_b32 v25, v25, v156, v160
    v_and_b32 v25, s1, v25
    v_cmp_ne_u32 vcc, 0, v25
    s_add_u32 s47, s47, 1
    s_cbranch_vccz Ld_g2_0
    s_and_b32 s46, s47, 15
    s_cbranch_scc1 Ll_g2_0
    buffer_wbl2 sc1
    buffer_inv sc1
    s_waitcnt vmcnt(0)
    s_cmp_lt_u32 s47, 0x2000
    s_cbranch_scc1 Ll_g2_0
Ld_g2_0:
    s_mov_b32 s53, s54
    s_branch Lb_g2_0
Lr_g2_5:
    s_mov_b32 s54, s53
    s_mov_b32 s47, 0
Ll_g2_5:
    s_add_u32 s53, s93, 0x17800
    buffer_load_dwordx4 v[72:75], v1, s[40:43], s53 offen offset:1024 sc1
    buffer_load_dwordx4 v[76:79], v1, s[40:43], s53 offen offset:2048 sc1
    buffer_load_dwordx4 v[80:83], v1, s[40:43], s53 offen offset:3072 sc1
    s_add_u32 s53, s93, 0x18800
    buffer_load_dwordx4 v[84:87], v1, s[40:43], s53 offen offset:0 sc1
    buffer_load_dwordx4 v[88:91], v1, s[40:43], s53 offen offset:1024 sc1
    buffer_load_dwordx4 v[92:95], v1, s[40:43], s53 offen offset:2048 sc1
    s_waitcnt vmcnt(0)
    v_xor_b32 v72, v41, v72
    v_xor_b32 v76, v41, v76
    v_xor_b32 v80, v41, v80
    v_xor_b32 v84, v41, v84
    v_xor_b32 v88, v41, v88
    v_xor_b32 v92, v41, v92
    v_or3_b32 v25, v72, v76, v80
    v_or3_b32 v25, v25, v84, v88
    v_bitop3_b32 v25, v25, v92, s1 bitop3:0xa8
    v_cmp_ne_u32 vcc, 0, v25
    s_add_u32 s47, s47, 1
    s_cbranch_vccz Ld_g2_5
    s_and_b32 s46, s47, 15
    s_cbranch_scc1 Ll_g2_5
    buffer_wbl2 sc1
    buffer_inv sc1
    s_waitcnt vmcnt(0)
    s_cmp_lt_u32 s47, 0x2000
    s_cbranch_scc1 Ll_g2_5
Ld_g2_5:
    s_mov_b32 s53, s54
    s_branch Lb_g2_5
Lr_g3_0:
    s_mov_b32 s54, s53
    s_mov_b32 s47, 0
Ll_g3_0:
    s_add_u32 s53, s93, 0x21c00
    buffer_load_dwordx4 v[168:171], v1, s[40:43], s53 offen offset:0 sc1
    buffer_load_dwordx4 v[172:175], v1, s[40:43], s53 offen offset:1024 sc1
    buffer_load_dwordx4 v[176:179], v1, s[40:43], s53 offen offset:2048 sc1
    buffer_load_dwordx4 v[180:183], v1, s[40:43], s53 offen offset:3072 sc1
    s_add_u32 s53, s93, 0x22c00
    buffer_load_dwordx4 v[184:187], v1, s[40:43], s53 offen offset:0 sc1
    s_waitcnt vmcnt(0)
    v_xor_b32 v168, v41, v168
    v_xor_b32 v172, v41, v172
    v_xor_b32 v176, v41, v176
    v_xor_b32 v180, v41, v180
    v_xor_b32 v184, v41, v184
    v_or3_b32 v25, v168, v172, v176
    v_or3_b32 v25, v25, v180, v184
    v_and_b32 v25, s1, v25
    v_cmp_ne_u32 vcc, 0, v25
    s_add_u32 s47, s47, 1
    s_cbranch_vccz Ld_g3_0
    s_and_b32 s46, s47, 15
    s_cbranch_scc1 Ll_g3_0
    buffer_wbl2 sc1
    buffer_inv sc1
    s_waitcnt vmcnt(0)
    s_cmp_lt_u32 s47, 0x2000
    s_cbranch_scc1 Ll_g3_0
Ld_g3_0:
    s_mov_b32 s53, s54
    s_branch Lb_g3_0
Lr_g3_5:
    s_mov_b32 s54, s53
    s_mov_b32 s47, 0
Ll_g3_5:
    s_add_u32 s53, s93, 0x22c00
    buffer_load_dwordx4 v[188:191], v1, s[40:43], s53 offen offset:1024 sc1
    buffer_load_dwordx4 v[192:195], v1, s[40:43], s53 offen offset:2048 sc1
    buffer_load_dwordx4 v[196:199], v1, s[40:43], s53 offen offset:3072 sc1
    s_add_u32 s53, s93, 0x23c00
    buffer_load_dwordx4 v[200:203], v1, s[40:43], s53 offen offset:0 sc1
    buffer_load_dwordx4 v[204:207], v1, s[40:43], s53 offen offset:1024 sc1
    buffer_load_dwordx4 v[208:211], v1, s[40:43], s53 offen offset:2048 sc1
    s_waitcnt vmcnt(0)
    v_xor_b32 v188, v41, v188
    v_xor_b32 v192, v41, v192
    v_xor_b32 v196, v41, v196
    v_xor_b32 v200, v41, v200
    v_xor_b32 v204, v41, v204
    v_xor_b32 v208, v41, v208
    v_or3_b32 v25, v188, v192, v196
    v_or3_b32 v25, v25, v200, v204
    v_bitop3_b32 v25, v25, v208, s1 bitop3:0xa8
    v_cmp_ne_u32 vcc, 0, v25
    s_add_u32 s47, s47, 1
    s_cbranch_vccz Ld_g3_5
    s_and_b32 s46, s47, 15
    s_cbranch_scc1 Ll_g3_5
    buffer_wbl2 sc1
    buffer_inv sc1
    s_waitcnt vmcnt(0)
    s_cmp_lt_u32 s47, 0x2000
    s_cbranch_scc1 Ll_g3_5
Ld_g3_5:
    s_mov_b32 s53, s54
    s_branch Lb_g3_5
L_end:
    s_endpgm
.section .rodata,"a"
.p2align 6
.amdhsa_kernel sequential_preLN__linear_kernel_hedgehog__glu_gated_bilinear__prompt_kernel
  .amdhsa_next_free_vgpr 512
  .amdhsa_next_free_sgpr 102
  .amdhsa_accum_offset 256
  .amdhsa_group_segment_fixed_size 0
  .amdhsa_kernarg_size 88
  .amdhsa_user_sgpr_count 2
  .amdhsa_user_sgpr_kernarg_segment_ptr 1
  .amdhsa_system_sgpr_workgroup_id_x 1
.end_amdhsa_kernel
```
